```python
import torch

def _softmax(x, axis=-1):
    return torch.softmax(x, dim=axis)
def _gelu(x):
    return torch.nn.functional.gelu(x, approximate="tanh")
def _silu(x):
    return torch.nn.functional.silu(x)
def _sigmoid(x):
    return torch.sigmoid(x)
def _layernorm(x, axis=-1, eps=1e-5):
    m = x.mean(dim=axis, keepdim=True)
    v = x.var(dim=axis, keepdim=True, unbiased=False)
    return (x - m) / torch.sqrt(v + eps)
def _scatter_add(tgt, idx, src, axis=0):
    return tgt.clone().index_add_(axis, idx, src)
def _segment_sum(src, seg, n):
    out = torch.zeros((n,) + src.shape[1:], dtype=src.dtype)
    return out.index_add_(0, seg, src)
def _pad(x, pw):
    flat = tuple(v for pair in reversed(pw) for v in pair)
    return torch.nn.functional.pad(x, flat)

kernel_name = 'gated_mix__ssm_conv_s4__geglu_ffn__prompt'

def setup_inputs():

    _w = (lambda a: (lambda t: t.to(torch.bfloat16) if t.is_floating_point() else t)(torch.as_tensor(a)))
    def _A_setup():
        B, L, D, N = 1, 2048, 512, 128
        A_re = -(lambda _x: torch.exp(torch.as_tensor(_x)))((lambda *s: torch.randn(*s, dtype=torch.bfloat16) * 3.2)(D, N))
        A_im = torch.pi * (lambda *s: torch.randn(*s, dtype=torch.bfloat16) * 0.05)(D, N)
        B_re = (lambda *s: torch.randn(*s, dtype=torch.bfloat16) * 0.1)(D, N)
        B_im = (lambda *s: torch.randn(*s, dtype=torch.bfloat16) * 0.1)(D, N)
        C_re = (lambda *s: torch.randn(*s, dtype=torch.bfloat16) * 0.1)(D, N)
        C_im = (lambda *s: torch.randn(*s, dtype=torch.bfloat16) * 0.1)(D, N)
        log_dt = (lambda *s: torch.randn(*s, dtype=torch.bfloat16) * 0.05)(D) * 0.5 - 4.0
        Dskip = (lambda *s: torch.randn(*s, dtype=torch.bfloat16) * 0.05)(D)
        return {
            "u": _w((lambda *s: torch.randn(*s, dtype=torch.bfloat16) * 0.05)(B, L, D)),
            "A_re": _w(A_re),
            "A_im": _w(A_im),
            "B_re": _w(B_re),
            "B_im": _w(B_im),
            "C_re": _w(C_re),
            "C_im": _w(C_im),
            "log_dt": _w(log_dt),
            "Dskip": _w(Dskip),
        }
    _A_in = _A_setup()

    def _B_setup():
        B, S, D, F = 1, 2048, 512, 1792
        return {
            "x": _w((lambda *s: torch.randn(*s, dtype=torch.bfloat16) * 0.05)(B, S, D)),
            "w_gate": _w((lambda *s: torch.randn(*s, dtype=torch.bfloat16) * 0.05)(D, F)),
            "w_up": _w((lambda *s: torch.randn(*s, dtype=torch.bfloat16) * 0.05)(D, F)),
            "w_down": _w((lambda *s: torch.randn(*s, dtype=torch.bfloat16) * 0.05)(F, D)),
        }
    _B_in = _B_setup()

    return {
        "A_u": _A_in["u"],
        "A_A_re": _A_in["A_re"],
        "A_A_im": _A_in["A_im"],
        "A_B_re": _A_in["B_re"],
        "A_B_im": _A_in["B_im"],
        "A_C_re": _A_in["C_re"],
        "A_C_im": _A_in["C_im"],
        "A_log_dt": _A_in["log_dt"],
        "A_Dskip": _A_in["Dskip"],
        "B_x": _B_in["x"],
        "B_w_gate": _B_in["w_gate"],
        "B_w_up": _B_in["w_up"],
        "B_w_down": _B_in["w_down"],
        "gate_w": _w((lambda *s: torch.randn(*s, dtype=torch.bfloat16) * 0.05)(512) * 16.0),
    }

def reference(A_u, A_A_re, A_A_im, A_B_re, A_B_im, A_C_re, A_C_im, A_log_dt, A_Dskip, B_x, B_w_gate, B_w_up, B_w_down, gate_w):
    def _A_ref(u, A_re, A_im, B_re, B_im, C_re, C_im, log_dt, Dskip):
        Bsz, L, D = u.shape
        dt = torch.exp(log_dt)[:, None]
        A = A_re + 1j * A_im
        Bc = B_re + 1j * B_im
        Cc = C_re + 1j * C_im
        logdA = dt * A
        dB = dt * Bc
        l = (lambda x, dt: x.to(dt))(torch.arange(L), A_re.dtype)
        P = torch.exp(logdA[:, :, None] * l[None, None, :])
        K = torch.einsum("dn,dnl,dn->dl", Cc, P, dB).real
        L2 = 2 * L
        Kp = _pad(K, ((0, 0), (0, L)))
        up = (lambda x, *d: x.permute(*d))(u, 0, 2, 1)
        up = _pad(up, ((0, 0), (0, 0), (0, L)))
        Kf = (lambda x, axes=(-2,-1): torch.fft.rfft2(x.float(), dim=axes))(Kp[:, None, :], axes=(-2, -1))
        Uf = (lambda x, axes=(-2,-1): torch.fft.rfft2(x.float(), dim=axes))(up[:, :, None, :], axes=(-2, -1))
        Yf = Uf * Kf[None, :, :, :]
        y = (lambda x, s, axes=(-2,-1): torch.fft.irfft2(x, s=s, dim=axes).to(torch.bfloat16))(Yf, (1, L2), axes=(-2, -1))[:, :, 0, :L]
        y = (lambda x, *d: x.permute(*d))(y, 0, 2, 1) + u * Dskip[None, None, :]
        return y

    def _B_ref(x, w_gate, w_up, w_down):
        return (_gelu(x @ w_gate) * (x @ w_up)) @ w_down

    x = A_u
    g = _sigmoid((x * gate_w).sum(-1, keepdims=True))
    a = _A_ref(x, A_A_re, A_A_im, A_B_re, A_B_im, A_C_re, A_C_im, A_log_dt, A_Dskip)
    b = _B_ref(x, B_w_gate, B_w_up, B_w_down)
    return g * a + (1 - g) * b
```

```asm
; @launch grid=(256,1,1) block=(512,1,1) lds=163840
.amdgcn_target "amdgcn-amd-amdhsa--gfx950"
.text
.globl gated_mix__ssm_conv_s4__geglu_ffn__prompt_kernel
.p2align 12
.type gated_mix__ssm_conv_s4__geglu_ffn__prompt_kernel,@function
gated_mix__ssm_conv_s4__geglu_ffn__prompt_kernel:
    s_cmp_ge_u32 s2, 256
    s_cbranch_scc1 L_exit
    s_load_dwordx16 s[64:79], s[0:1], 8
    s_load_dwordx2 s[8:9], s[0:1], 0
    s_load_dwordx4 s[12:15], s[0:1], 80
    s_load_dwordx8 s[56:63], s[0:1], 96
    s_load_dwordx2 s[20:21], s[0:1], 128
    v_lshrrev_b32 v2, 6, v0
    v_and_b32 v1, 63, v0
    v_mov_b32 v251, 0
    v_mov_b32 v16, 161568
    v_mov_b32 v253, 1
    ds_write_b32 v16, v251
    ds_write_b32 v16, v251 offset:4
    v_and_b32 v3, 255, v0
    v_readfirstlane_b32 s24, v2
    s_lshl_b32 s3, s2, 8
    v_add_u32 v3, s3, v3
    v_lshlrev_b32 v3, 1, v3
    v_lshrrev_b32 v4, 7, v3
    v_and_b32 v4, 0xfffffffe, v4
    s_and_b32 s36, s24, 3
    s_and_b32 s3, s2, 7
    s_lshr_b32 s4, s2, 3
    s_lshr_b32 s32, s3, 1
    s_lshl_b32 s32, s32, 2
    s_and_b32 s5, s4, 3
    s_add_u32 s32, s32, s5
    s_lshl_b32 s38, s3, 2
    s_add_u32 s38, s38, s5
    s_and_b32 s33, s3, 1
    s_mul_i32 s33, s33, 7
    s_lshr_b32 s39, s4, 2
    s_add_u32 s33, s33, s39
    s_xor_b32 s39, s39, 4
    s_lshl_b32 s25, s32, 17
    s_lshl_b32 s5, s24, 14
    s_add_u32 s25, s25, s5
    s_mul_i32 s26, s24, 14336
    s_lshl_b32 s5, s33, 8
    s_add_u32 s26, s26, s5
    s_and_b32 s45, s3, 6
    s_lshl_b32 s44, s45, 7
    s_lshl_b32 s45, s45, 1
    s_lshl_b32 s27, s24, 11
    s_add_u32 s28, s27, 65536
    v_lshrrev_b32 v16, 4, v1
    v_and_b32 v17, 7, v1
    v_xor_b32 v18, v17, v16
    v_lshrrev_b32 v19, 3, v1
    v_lshlrev_b32 v19, 10, v19
    v_lshl_add_u32 v240, v18, 4, v19
    v_xor_b32 v241, 64, v240
    v_add_u32 v241, 7168, v241
    v_lshlrev_b32 v17, 2, v16
    v_and_b32 v242, 15, v1
    v_xor_b32 v242, v242, v17
    s_and_b32 s5, s24, 2
    v_xor_b32 v242, s5, v242
    v_lshlrev_b32 v242, 4, v242
    v_mul_u32_u24 v16, 3584, v16
    v_add_u32 v242, v242, v16
    s_mov_b32 s10, 0x200000
    s_mov_b32 s11, 0x00020000
    s_mov_b32 s18, 1836032
    s_mov_b32 s19, 0x00020000
    s_mov_b32 s22, 268435456
    s_mov_b32 s23, 0x00020000
    s_waitcnt lgkmcnt(0)
    s_sub_u32 s16, s14, 1024
    s_subb_u32 s17, s15, 0
    s_mov_b32 s14, 1835008
    s_mov_b32 s15, 0x00020000
    global_load_ushort v120, v4, s[76:77]
    global_load_ushort v121, v3, s[64:65]
    global_load_ushort v122, v3, s[66:67]
    s_cmp_lt_u32 s24, 4
    s_cbranch_scc1 L_role_a
    s_cmp_ge_u32 s2, 224
    s_cbranch_scc1 L_mv_head
    s_add_u32 s46, s44, 0
    s_and_b32 s46, s46, 1023
    s_add_u32 s46, s46, s25
    s_add_u32 m0, s28, 4294959104
    s_add_u32 s41, s46, 4294901760
    buffer_load_dwordx4 v240, s[8:11], s41 offen lds
    buffer_load_dwordx4 v241, s[8:11], s41 offen offset:1024 lds
    s_add_u32 m0, s28, 0
    s_add_u32 s41, s46, 0
    buffer_load_dwordx4 v240, s[8:11], s41 offen lds
    buffer_load_dwordx4 v241, s[8:11], s41 offen offset:1024 lds
    s_add_u32 s46, s45, 0
    s_and_b32 s46, s46, 15
    s_mul_i32 s46, s46, 114688
    s_add_u32 s46, s46, s26
    s_add_u32 m0, s27, 4294959104
    s_add_u32 s41, s46, 4294909952
    buffer_load_dwordx4 v242, s[12:15], s41 offen lds
    buffer_load_dwordx4 v242, s[16:19], s41 offen offset:1024 lds
    s_add_u32 m0, s27, 0
    s_add_u32 s41, s46, 0
    buffer_load_dwordx4 v242, s[12:15], s41 offen lds
    buffer_load_dwordx4 v242, s[16:19], s41 offen offset:1024 lds
    s_add_u32 s46, s45, 1
    s_and_b32 s46, s46, 15
    s_mul_i32 s46, s46, 114688
    s_add_u32 s46, s46, s26
    s_add_u32 m0, s27, 8192
    s_add_u32 s41, s46, 4294909952
    buffer_load_dwordx4 v242, s[12:15], s41 offen lds
    buffer_load_dwordx4 v242, s[16:19], s41 offen offset:1024 lds
    s_add_u32 m0, s27, 16384
    s_add_u32 s41, s46, 0
    buffer_load_dwordx4 v242, s[12:15], s41 offen lds
    buffer_load_dwordx4 v242, s[16:19], s41 offen offset:1024 lds
    s_cmp_eq_u32 s24, 4
    s_cbranch_scc1 L_pad_rb
    s_cmp_eq_u32 s24, 5
    s_cbranch_scc1 L_pad_su
    s_cmp_eq_u32 s24, 6
    s_cbranch_scc1 L_pad_tb0
    s_cmp_eq_u32 s24, 7
    s_cbranch_scc1 L_pad_rb1
L_warm_ret0:
    s_branch L_role_b
L_mv_head:
    s_sub_u32 s6, s2, 224
    s_lshl_b32 s3, s6, 16
    s_lshl_b32 s4, s36, 14
    s_add_u32 s3, s3, s4
    s_mul_i32 s4, s36, 16896
    v_lshlrev_b32 v16, 4, v1
    s_add_u32 s5, s3, 16384
L_mv_ld:
    s_mov_b32 m0, s4
    s_add_u32 s4, s4, 1056
    buffer_load_dwordx4 v16, s[8:11], s3 offen lds
    s_add_u32 s3, s3, 1024
    s_cmp_lt_u32 s3, s5
    s_cbranch_scc1 L_mv_ld
    global_load_dwordx4 v[128:131], v16, s[58:59]
    v_add_u32 v132, 67584, v16
    s_branch L_mv_head2
L_role_a:
    global_load_ushort v123, v3, s[68:69]
    global_load_ushort v124, v3, s[70:71]
    global_load_ushort v125, v3, s[72:73]
    global_load_ushort v126, v3, s[74:75]
    s_mov_b32 s100, 0
    v_mov_b64 v[40:41], 0
    v_mov_b64 v[42:43], 0
    v_and_b32 v127, 127, v0
    v_lshlrev_b32 v127, 2, v127
    s_lshr_b32 s6, s36, 1
    s_mul_i32 s4, s6, 30096
    s_add_u32 s4, s4, 98304
    v_add_u32 v127, s4, v127
    s_mov_b32 s54, 0x3fb8aa3b
    s_mov_b32 s55, 0x32a57060
    s_mov_b32 s68, s56
    s_mov_b32 s69, s57
    s_mov_b32 s70, 1835008
    s_mov_b32 s71, 0x00020000
    s_and_b32 s67, s2, 7
    s_cmp_eq_u32 s67, 7
    s_cselect_b32 s67, 3, s67
    s_and_b32 s3, s39, 1
    s_mul_i32 s3, s3, 0
    s_add_u32 s67, s67, s3
    s_mul_i32 s3, s67, 37
    s_lshr_b32 s3, s3, 8
    s_mul_i32 s3, s3, 7
    s_sub_u32 s67, s67, s3
    s_lshl_b32 s67, s67, 2
    s_mov_b32 s42, 4194304
    s_lshl_b32 s3, s2, 2
    s_load_dword s48, s[78:79], s3
    v_lshrrev_b32 v16, 2, v1
    v_and_b32 v16, 3, v16
    v_xor_b32 v17, s36, v16
    v_lshlrev_b32 v72, 8, v16
    v_lshl_add_u32 v72, v17, 6, v72
    v_lshrrev_b32 v16, 4, v1
    v_lshl_add_u32 v72, v16, 12, v72
    v_and_b32 v17, 1, v16
    v_lshl_add_u32 v72, v17, 5, v72
    v_and_b32 v17, 3, v1
    v_lshl_add_u32 v72, v17, 3, v72
    v_xor_b32 v73, 32, v72
    v_lshrrev_b32 v17, 1, v1
    v_and_b32 v17, 7, v17
    v_xor_b32 v17, v17, v16
    v_and_b32 v18, 15, v1
    v_lshlrev_b32 v74, 7, v18
    v_lshl_add_u32 v74, v17, 4, v74
    v_add_u32 v74, 65536, v74
    v_xor_b32 v75, 64, v74
    v_lshlrev_b32 v10, 4, v18
    v_lshl_add_u32 v10, v16, 9, v10
    v_mov_b32 v12, 0xc0135761
    v_mov_b32 v13, v12
    v_mov_b32 v14, 1
    v_mul_u32_u24 v15, 7168, v1
    s_mul_i32 s43, s32, 448
    s_lshl_b32 s5, s33, 2
    s_add_u32 s5, s5, s36
    s_lshl_b32 s4, s5, 1
    s_add_u32 s43, s43, s4
    s_lshl_b32 s43, s43, 10
    s_mul_i32 s3, s32, 112
    s_add_u32 s3, s3, s5
    s_lshl_b32 s3, s3, 7
    s_add_u32 s49, s3, 11567104
    s_add_u32 s31, s49, 7168
    s_mov_b32 s34, 0xbdd2d3e8
    s_mov_b32 s35, s34
    s_mov_b32 s30, 0
    s_lshl_b32 s50, s2, 13
    s_add_u32 s50, s50, 9437184
    s_lshl_b32 s3, s2, 2
    s_add_u32 s3, s3, s36
    s_lshl_b32 s3, s3, 7
    s_add_u32 s51, s3, 11796480
    s_branch L_skip_su
L_pad_su:
    s_branch L_warm_ret0
L_skip_su:
    s_cmp_ge_u32 s2, 224
    s_cbranch_scc1 L_mv_a
    v_mfma_f32_32x32x16_bf16 v[128:143], v[40:43], v[40:43], 0
    v_mfma_f32_32x32x16_bf16 v[144:159], v[40:43], v[40:43], 0
    v_mfma_f32_32x32x16_bf16 v[160:175], v[40:43], v[40:43], 0
    v_mfma_f32_32x32x16_bf16 v[176:191], v[40:43], v[40:43], 0
    v_mfma_f32_32x32x16_bf16 v[192:207], v[40:43], v[40:43], 0
    v_mfma_f32_32x32x16_bf16 v[208:223], v[40:43], v[40:43], 0
    v_mfma_f32_32x32x16_bf16 v[224:239], v[40:43], v[40:43], 0
    v_mfma_f32_32x32x16_bf16 v[240:255], v[40:43], v[40:43], 0
    s_waitcnt vmcnt(0)
    s_cmp_ge_u32 s24, 2
    s_cbranch_scc1 L_a_tab
    s_lshl_b32 s3, s2, 1
    s_add_u32 s3, s3, s24
    s_mul_i32 s3, s3, 4736
    v_min_u32 v112, 36, v1
    v_lshlrev_b32 v112, 7, v112
    buffer_load_dword v76, v112, s[8:11], s3 offen
L_a_tab:
    v_lshlrev_b32 v120, 16, v120
    v_lshlrev_b32 v16, 16, v121
    v_lshlrev_b32 v17, 16, v122
    v_mul_f32 v18, s54, v120
    v_fma_f32 v19, v120, s54, -v18
    v_fma_f32 v19, v120, s55, v19
    v_exp_f32 v18, v18
    v_mul_f32 v19, 0x3f317218, v19
    v_fmac_f32 v18, v18, v19
    v_cvt_pk_bf16_f32 v18, 0, v18
    v_mul_f32 v16, v18, v16
    v_mul_f32 v17, v18, v17
    v_mul_f32 v16, s54, v16
    v_mul_f32 v17, 0.15915494, v17
    v_exp_f32 v40, v16
    v_fract_f32 v41, v17
    v_cos_f32 v44, v41
    v_sin_f32 v45, v41
    v_mul_f32 v44, v40, v44
    v_mul_f32 v45, v40, v45
    v_mul_f32 v42, 0x43000000, v16
    v_mul_f32 v43, 0x43000000, v17
    v_exp_f32 v42, v42
    v_fract_f32 v43, v43
    v_cos_f32 v28, v43
    v_sin_f32 v29, v43
    v_mul_f32 v28, v42, v28
    v_mul_f32 v29, v42, v29
    v_cvt_pk_bf16_f32 v108, v44, v45
    ds_write_b32 v127, v108 offset:8976
    v_cvt_pk_bf16_f32 v109, v28, v29
    ds_write_b32 v127, v109 offset:12672
    v_mul_f32 v40, 0x41000000, v16
    v_mul_f32 v41, 0x41000000, v17
    v_exp_f32 v40, v40
    v_fract_f32 v41, v41
    v_cos_f32 v24, v41
    v_sin_f32 v25, v41
    v_mul_f32 v24, v40, v24
    v_mul_f32 v25, v40, v25
    v_lshlrev_b32 v32, 16, v123
    v_lshlrev_b32 v33, 16, v124
    v_lshlrev_b32 v36, 16, v125
    v_lshlrev_b32 v37, 16, v126
    v_mul_f32 v32, v18, v32
    v_mul_f32 v33, v18, v33
    v_pk_mul_f32 v[20:21], v[36:37], v[32:33] op_sel_hi:[0,1]
    v_pk_fma_f32 v[20:21], v[36:37], v[32:33], v[20:21] op_sel:[1,1,0] op_sel_hi:[1,0,1] neg_lo:[0,1,0]
    v_cvt_pk_bf16_f32 v110, v20, -v21
    ds_write_b32 v127, v110 offset:0
    s_branch L_skip_tb0
L_pad_tb0:
    s_branch L_warm_ret0
L_skip_tb0:
    v_pk_mul_f32 v[52:53], v[44:45], v[28:29] op_sel_hi:[0,1]
    v_pk_fma_f32 v[52:53], v[44:45], v[28:29], v[52:53] op_sel:[1,1,0] op_sel_hi:[1,0,1] neg_lo:[0,1,0]
    v_pk_mul_f32 v[22:23], v[20:21], v[24:25] op_sel_hi:[0,1]
    v_pk_fma_f32 v[22:23], v[20:21], v[24:25], v[22:23] op_sel:[1,1,0] op_sel_hi:[1,0,1] neg_lo:[0,1,0]
    v_cvt_pk_bf16_f32 v111, v22, -v23
    ds_write_b32 v127, v111 offset:528
    v_cvt_pk_bf16_f32 v108, v52, v53
    ds_write_b32 v127, v108 offset:13200
    v_pk_mul_f32 v[48:49], v[44:45], v[44:45] op_sel_hi:[0,1]
    v_pk_fma_f32 v[48:49], v[44:45], v[44:45], v[48:49] op_sel:[1,1,0] op_sel_hi:[1,0,1] neg_lo:[0,1,0]
    v_pk_mul_f32 v[20:21], v[22:23], v[24:25] op_sel_hi:[0,1]
    v_pk_fma_f32 v[20:21], v[22:23], v[24:25], v[20:21] op_sel:[1,1,0] op_sel_hi:[1,0,1] neg_lo:[0,1,0]
    v_cvt_pk_bf16_f32 v109, v20, -v21
    ds_write_b32 v127, v109 offset:1056
    v_cvt_pk_bf16_f32 v110, v48, v49
    ds_write_b32 v127, v110 offset:9504
    v_pk_mul_f32 v[52:53], v[48:49], v[28:29] op_sel_hi:[0,1]
    v_pk_fma_f32 v[52:53], v[48:49], v[28:29], v[52:53] op_sel:[1,1,0] op_sel_hi:[1,0,1] neg_lo:[0,1,0]
    v_pk_mul_f32 v[22:23], v[20:21], v[24:25] op_sel_hi:[0,1]
    v_pk_fma_f32 v[22:23], v[20:21], v[24:25], v[22:23] op_sel:[1,1,0] op_sel_hi:[1,0,1] neg_lo:[0,1,0]
    v_cvt_pk_bf16_f32 v111, v22, -v23
    ds_write_b32 v127, v111 offset:1584
    v_cvt_pk_bf16_f32 v108, v52, v53
    ds_write_b32 v127, v108 offset:13728
    v_pk_mul_f32 v[50:51], v[48:49], v[44:45] op_sel_hi:[0,1]
    v_pk_fma_f32 v[50:51], v[48:49], v[44:45], v[50:51] op_sel:[1,1,0] op_sel_hi:[1,0,1] neg_lo:[0,1,0]
    v_pk_mul_f32 v[20:21], v[22:23], v[24:25] op_sel_hi:[0,1]
    v_pk_fma_f32 v[20:21], v[22:23], v[24:25], v[20:21] op_sel:[1,1,0] op_sel_hi:[1,0,1] neg_lo:[0,1,0]
    v_cvt_pk_bf16_f32 v109, v20, -v21
    ds_write_b32 v127, v109 offset:2112
    v_cvt_pk_bf16_f32 v110, v50, v51
    ds_write_b32 v127, v110 offset:10032
    v_pk_mul_f32 v[54:55], v[50:51], v[28:29] op_sel_hi:[0,1]
    v_pk_fma_f32 v[54:55], v[50:51], v[28:29], v[54:55] op_sel:[1,1,0] op_sel_hi:[1,0,1] neg_lo:[0,1,0]
    v_pk_mul_f32 v[22:23], v[20:21], v[24:25] op_sel_hi:[0,1]
    v_pk_fma_f32 v[22:23], v[20:21], v[24:25], v[22:23] op_sel:[1,1,0] op_sel_hi:[1,0,1] neg_lo:[0,1,0]
    v_cvt_pk_bf16_f32 v111, v22, -v23
    ds_write_b32 v127, v111 offset:2640
    v_cvt_pk_bf16_f32 v108, v54, v55
    ds_write_b32 v127, v108 offset:14256
    v_pk_mul_f32 v[48:49], v[50:51], v[44:45] op_sel_hi:[0,1]
    v_pk_fma_f32 v[48:49], v[50:51], v[44:45], v[48:49] op_sel:[1,1,0] op_sel_hi:[1,0,1] neg_lo:[0,1,0]
    v_pk_mul_f32 v[20:21], v[22:23], v[24:25] op_sel_hi:[0,1]
    v_pk_fma_f32 v[20:21], v[22:23], v[24:25], v[20:21] op_sel:[1,1,0] op_sel_hi:[1,0,1] neg_lo:[0,1,0]
    v_cvt_pk_bf16_f32 v109, v20, -v21
    ds_write_b32 v127, v109 offset:3168
    v_cvt_pk_bf16_f32 v110, v48, v49
    ds_write_b32 v127, v110 offset:10560
    v_pk_mul_f32 v[52:53], v[48:49], v[28:29] op_sel_hi:[0,1]
    v_pk_fma_f32 v[52:53], v[48:49], v[28:29], v[52:53] op_sel:[1,1,0] op_sel_hi:[1,0,1] neg_lo:[0,1,0]
    v_pk_mul_f32 v[22:23], v[20:21], v[24:25] op_sel_hi:[0,1]
    v_pk_fma_f32 v[22:23], v[20:21], v[24:25], v[22:23] op_sel:[1,1,0] op_sel_hi:[1,0,1] neg_lo:[0,1,0]
    v_cvt_pk_bf16_f32 v111, v22, -v23
    ds_write_b32 v127, v111 offset:3696
    v_cvt_pk_bf16_f32 v108, v52, v53
    ds_write_b32 v127, v108 offset:14784
    v_pk_mul_f32 v[50:51], v[48:49], v[44:45] op_sel_hi:[0,1]
    v_pk_fma_f32 v[50:51], v[48:49], v[44:45], v[50:51] op_sel:[1,1,0] op_sel_hi:[1,0,1] neg_lo:[0,1,0]
    v_pk_mul_f32 v[20:21], v[22:23], v[24:25] op_sel_hi:[0,1]
    v_pk_fma_f32 v[20:21], v[22:23], v[24:25], v[20:21] op_sel:[1,1,0] op_sel_hi:[1,0,1] neg_lo:[0,1,0]
    v_cvt_pk_bf16_f32 v109, v20, -v21
    ds_write_b32 v127, v109 offset:4224
    v_cvt_pk_bf16_f32 v110, v50, v51
    ds_write_b32 v127, v110 offset:11088
    v_pk_mul_f32 v[54:55], v[50:51], v[28:29] op_sel_hi:[0,1]
    v_pk_fma_f32 v[54:55], v[50:51], v[28:29], v[54:55] op_sel:[1,1,0] op_sel_hi:[1,0,1] neg_lo:[0,1,0]
    v_pk_mul_f32 v[22:23], v[20:21], v[24:25] op_sel_hi:[0,1]
    v_pk_fma_f32 v[22:23], v[20:21], v[24:25], v[22:23] op_sel:[1,1,0] op_sel_hi:[1,0,1] neg_lo:[0,1,0]
    v_cvt_pk_bf16_f32 v111, v22, -v23
    ds_write_b32 v127, v111 offset:4752
    v_cvt_pk_bf16_f32 v108, v54, v55
    ds_write_b32 v127, v108 offset:15312
    v_pk_mul_f32 v[48:49], v[50:51], v[44:45] op_sel_hi:[0,1]
    v_pk_fma_f32 v[48:49], v[50:51], v[44:45], v[48:49] op_sel:[1,1,0] op_sel_hi:[1,0,1] neg_lo:[0,1,0]
    v_pk_mul_f32 v[20:21], v[22:23], v[24:25] op_sel_hi:[0,1]
    v_pk_fma_f32 v[20:21], v[22:23], v[24:25], v[20:21] op_sel:[1,1,0] op_sel_hi:[1,0,1] neg_lo:[0,1,0]
    v_cvt_pk_bf16_f32 v109, v20, -v21
    ds_write_b32 v127, v109 offset:5280
    v_cvt_pk_bf16_f32 v110, v48, v49
    ds_write_b32 v127, v110 offset:11616
    v_pk_mul_f32 v[52:53], v[48:49], v[28:29] op_sel_hi:[0,1]
    v_pk_fma_f32 v[52:53], v[48:49], v[28:29], v[52:53] op_sel:[1,1,0] op_sel_hi:[1,0,1] neg_lo:[0,1,0]
    v_pk_mul_f32 v[22:23], v[20:21], v[24:25] op_sel_hi:[0,1]
    v_pk_fma_f32 v[22:23], v[20:21], v[24:25], v[22:23] op_sel:[1,1,0] op_sel_hi:[1,0,1] neg_lo:[0,1,0]
    v_cvt_pk_bf16_f32 v111, v22, -v23
    ds_write_b32 v127, v111 offset:5808
    v_cvt_pk_bf16_f32 v108, v52, v53
    ds_write_b32 v127, v108 offset:15840
    v_pk_mul_f32 v[50:51], v[48:49], v[44:45] op_sel_hi:[0,1]
    v_pk_fma_f32 v[50:51], v[48:49], v[44:45], v[50:51] op_sel:[1,1,0] op_sel_hi:[1,0,1] neg_lo:[0,1,0]
    v_pk_mul_f32 v[20:21], v[22:23], v[24:25] op_sel_hi:[0,1]
    v_pk_fma_f32 v[20:21], v[22:23], v[24:25], v[20:21] op_sel:[1,1,0] op_sel_hi:[1,0,1] neg_lo:[0,1,0]
    v_cvt_pk_bf16_f32 v109, v20, -v21
    ds_write_b32 v127, v109 offset:6336
    v_cvt_pk_bf16_f32 v110, v50, v51
    ds_write_b32 v127, v110 offset:12144
    v_pk_mul_f32 v[54:55], v[50:51], v[28:29] op_sel_hi:[0,1]
    v_pk_fma_f32 v[54:55], v[50:51], v[28:29], v[54:55] op_sel:[1,1,0] op_sel_hi:[1,0,1] neg_lo:[0,1,0]
    v_pk_mul_f32 v[22:23], v[20:21], v[24:25] op_sel_hi:[0,1]
    v_pk_fma_f32 v[22:23], v[20:21], v[24:25], v[22:23] op_sel:[1,1,0] op_sel_hi:[1,0,1] neg_lo:[0,1,0]
    v_cvt_pk_bf16_f32 v111, v22, -v23
    ds_write_b32 v127, v111 offset:6864
    v_cvt_pk_bf16_f32 v108, v54, v55
    ds_write_b32 v127, v108 offset:16368
    v_pk_mul_f32 v[20:21], v[22:23], v[24:25] op_sel_hi:[0,1]
    v_pk_fma_f32 v[20:21], v[22:23], v[24:25], v[20:21] op_sel:[1,1,0] op_sel_hi:[1,0,1] neg_lo:[0,1,0]
    v_cvt_pk_bf16_f32 v109, v20, -v21
    ds_write_b32 v127, v109 offset:7392
    v_pk_mul_f32 v[22:23], v[20:21], v[24:25] op_sel_hi:[0,1]
    v_pk_fma_f32 v[22:23], v[20:21], v[24:25], v[22:23] op_sel:[1,1,0] op_sel_hi:[1,0,1] neg_lo:[0,1,0]
    v_cvt_pk_bf16_f32 v110, v22, -v23
    ds_write_b32 v127, v110 offset:7920
    s_cmp_ge_u32 s2, 224
    s_cbranch_scc1 L_mv_a2
    s_lshl_b32 s3, s2, 2
    s_add_u32 s3, s3, s24
    s_lshl_b32 s3, s3, 11
    v_and_b32 v112, 15, v1
    v_lshlrev_b32 v112, 7, v112
    buffer_load_dword v76, v112, s[68:71], s3 offen
    s_cmp_eq_u32 s24, 0
    s_cbranch_scc1 L_pad_rb2
    s_cmp_eq_u32 s24, 1
    s_cbranch_scc1 L_pad_g1b
    s_cmp_eq_u32 s24, 2
    s_cbranch_scc1 L_pad_ea0
    s_cmp_eq_u32 s24, 3
    s_cbranch_scc1 L_pad_ea1
L_warm_ret1:
    s_setprio 1
    s_waitcnt lgkmcnt(0)
    s_barrier
    ds_read_b64_tr_b16 v[16:17], v72 offset:0
    ds_read_b64_tr_b16 v[18:19], v72 offset:2048
    ds_read_b64_tr_b16 v[20:21], v73 offset:0
    ds_read_b64_tr_b16 v[22:23], v73 offset:2048
    ds_read_b64_tr_b16 v[24:25], v72 offset:1024
    ds_read_b64_tr_b16 v[26:27], v72 offset:3072
    ds_read_b64_tr_b16 v[28:29], v73 offset:1024
    ds_read_b64_tr_b16 v[30:31], v73 offset:3072
    ds_read_b128 v[80:83], v74 offset:0
    ds_read_b128 v[84:87], v74 offset:2048
    ds_read_b128 v[88:91], v74 offset:4096
    ds_read_b128 v[92:95], v74 offset:6144
L_g1_loop:
    s_waitcnt lgkmcnt(0)
    v_mfma_f32_16x16x32_bf16 v[128:131], v[16:19], v[80:83], v[128:131]
    ds_read_b128 v[96:99], v74 offset:8192
    v_mfma_f32_16x16x32_bf16 v[132:135], v[20:23], v[80:83], v[132:135]
    ds_read_b128 v[100:103], v74 offset:10240
    v_mfma_f32_16x16x32_bf16 v[144:147], v[24:27], v[80:83], v[144:147]
    ds_read_b128 v[104:107], v74 offset:12288
    v_mfma_f32_16x16x32_bf16 v[148:151], v[28:31], v[80:83], v[148:151]
    ds_read_b128 v[108:111], v74 offset:14336
    v_mfma_f32_16x16x32_bf16 v[156:159], v[28:31], v[84:87], v[156:159]
    v_mfma_f32_16x16x32_bf16 v[152:155], v[24:27], v[84:87], v[152:155]
    v_mfma_f32_16x16x32_bf16 v[140:143], v[20:23], v[84:87], v[140:143]
    v_mfma_f32_16x16x32_bf16 v[136:139], v[16:19], v[84:87], v[136:139]
    v_mfma_f32_16x16x32_bf16 v[160:163], v[16:19], v[88:91], v[160:163]
    v_mfma_f32_16x16x32_bf16 v[164:167], v[20:23], v[88:91], v[164:167]
    v_mfma_f32_16x16x32_bf16 v[176:179], v[24:27], v[88:91], v[176:179]
    v_mfma_f32_16x16x32_bf16 v[180:183], v[28:31], v[88:91], v[180:183]
    v_mfma_f32_16x16x32_bf16 v[188:191], v[28:31], v[92:95], v[188:191]
    v_mfma_f32_16x16x32_bf16 v[184:187], v[24:27], v[92:95], v[184:187]
    v_mfma_f32_16x16x32_bf16 v[172:175], v[20:23], v[92:95], v[172:175]
    v_mfma_f32_16x16x32_bf16 v[168:171], v[16:19], v[92:95], v[168:171]
    s_waitcnt lgkmcnt(0)
    s_barrier
    ds_read_b64_tr_b16 v[32:33], v72 offset:16384
    ds_read_b64_tr_b16 v[34:35], v72 offset:18432
    ds_read_b128 v[80:83], v75 offset:0
    ds_read_b64_tr_b16 v[36:37], v73 offset:16384
    ds_read_b64_tr_b16 v[38:39], v73 offset:18432
    ds_read_b64_tr_b16 v[40:41], v72 offset:17408
    v_mfma_f32_16x16x32_bf16 v[192:195], v[16:19], v[96:99], v[192:195]
    ds_read_b64_tr_b16 v[42:43], v72 offset:19456
    v_mfma_f32_16x16x32_bf16 v[196:199], v[20:23], v[96:99], v[196:199]
    ds_read_b64_tr_b16 v[44:45], v73 offset:17408
    v_mfma_f32_16x16x32_bf16 v[208:211], v[24:27], v[96:99], v[208:211]
    ds_read_b64_tr_b16 v[46:47], v73 offset:19456
    v_mfma_f32_16x16x32_bf16 v[212:215], v[28:31], v[96:99], v[212:215]
    ds_read_b128 v[84:87], v75 offset:2048
    v_mfma_f32_16x16x32_bf16 v[220:223], v[28:31], v[100:103], v[220:223]
    ds_read_b128 v[88:91], v75 offset:4096
    v_mfma_f32_16x16x32_bf16 v[216:219], v[24:27], v[100:103], v[216:219]
    ds_read_b128 v[92:95], v75 offset:6144
    v_mfma_f32_16x16x32_bf16 v[204:207], v[20:23], v[100:103], v[204:207]
    v_mfma_f32_16x16x32_bf16 v[200:203], v[16:19], v[100:103], v[200:203]
    v_mfma_f32_16x16x32_bf16 v[224:227], v[16:19], v[104:107], v[224:227]
    v_mfma_f32_16x16x32_bf16 v[228:231], v[20:23], v[104:107], v[228:231]
    v_mfma_f32_16x16x32_bf16 v[240:243], v[24:27], v[104:107], v[240:243]
    v_mfma_f32_16x16x32_bf16 v[244:247], v[28:31], v[104:107], v[244:247]
    v_mfma_f32_16x16x32_bf16 v[252:255], v[28:31], v[108:111], v[252:255]
    v_mfma_f32_16x16x32_bf16 v[248:251], v[24:27], v[108:111], v[248:251]
    v_mfma_f32_16x16x32_bf16 v[236:239], v[20:23], v[108:111], v[236:239]
    v_mfma_f32_16x16x32_bf16 v[232:235], v[16:19], v[108:111], v[232:235]
    s_waitcnt lgkmcnt(0)
    v_mfma_f32_16x16x32_bf16 v[128:131], v[32:35], v[80:83], v[128:131]
    ds_read_b128 v[96:99], v75 offset:8192
    v_mfma_f32_16x16x32_bf16 v[132:135], v[36:39], v[80:83], v[132:135]
    ds_read_b128 v[100:103], v75 offset:10240
    v_mfma_f32_16x16x32_bf16 v[144:147], v[40:43], v[80:83], v[144:147]
    ds_read_b128 v[104:107], v75 offset:12288
    v_mfma_f32_16x16x32_bf16 v[148:151], v[44:47], v[80:83], v[148:151]
    ds_read_b128 v[108:111], v75 offset:14336
    v_mfma_f32_16x16x32_bf16 v[156:159], v[44:47], v[84:87], v[156:159]
    v_mfma_f32_16x16x32_bf16 v[152:155], v[40:43], v[84:87], v[152:155]
    v_mfma_f32_16x16x32_bf16 v[140:143], v[36:39], v[84:87], v[140:143]
    v_mfma_f32_16x16x32_bf16 v[136:139], v[32:35], v[84:87], v[136:139]
    v_mfma_f32_16x16x32_bf16 v[160:163], v[32:35], v[88:91], v[160:163]
    v_mfma_f32_16x16x32_bf16 v[164:167], v[36:39], v[88:91], v[164:167]
    v_mfma_f32_16x16x32_bf16 v[176:179], v[40:43], v[88:91], v[176:179]
    v_mfma_f32_16x16x32_bf16 v[180:183], v[44:47], v[88:91], v[180:183]
    v_mfma_f32_16x16x32_bf16 v[188:191], v[44:47], v[92:95], v[188:191]
    v_mfma_f32_16x16x32_bf16 v[184:187], v[40:43], v[92:95], v[184:187]
    v_mfma_f32_16x16x32_bf16 v[172:175], v[36:39], v[92:95], v[172:175]
    v_mfma_f32_16x16x32_bf16 v[168:171], v[32:35], v[92:95], v[168:171]
    s_waitcnt lgkmcnt(0)
    s_barrier
    ds_read_b64_tr_b16 v[16:17], v72 offset:32768
    ds_read_b64_tr_b16 v[18:19], v72 offset:34816
    ds_read_b128 v[80:83], v74 offset:16384
    ds_read_b64_tr_b16 v[20:21], v73 offset:32768
    ds_read_b64_tr_b16 v[22:23], v73 offset:34816
    ds_read_b64_tr_b16 v[24:25], v72 offset:33792
    v_mfma_f32_16x16x32_bf16 v[192:195], v[32:35], v[96:99], v[192:195]
    ds_read_b64_tr_b16 v[26:27], v72 offset:35840
    v_mfma_f32_16x16x32_bf16 v[196:199], v[36:39], v[96:99], v[196:199]
    ds_read_b64_tr_b16 v[28:29], v73 offset:33792
    v_mfma_f32_16x16x32_bf16 v[208:211], v[40:43], v[96:99], v[208:211]
    ds_read_b64_tr_b16 v[30:31], v73 offset:35840
    v_mfma_f32_16x16x32_bf16 v[212:215], v[44:47], v[96:99], v[212:215]
    ds_read_b128 v[84:87], v74 offset:18432
    v_mfma_f32_16x16x32_bf16 v[220:223], v[44:47], v[100:103], v[220:223]
    ds_read_b128 v[88:91], v74 offset:20480
    v_mfma_f32_16x16x32_bf16 v[216:219], v[40:43], v[100:103], v[216:219]
    ds_read_b128 v[92:95], v74 offset:22528
    v_mfma_f32_16x16x32_bf16 v[204:207], v[36:39], v[100:103], v[204:207]
    v_mfma_f32_16x16x32_bf16 v[200:203], v[32:35], v[100:103], v[200:203]
    v_mfma_f32_16x16x32_bf16 v[224:227], v[32:35], v[104:107], v[224:227]
    v_mfma_f32_16x16x32_bf16 v[228:231], v[36:39], v[104:107], v[228:231]
    v_mfma_f32_16x16x32_bf16 v[240:243], v[40:43], v[104:107], v[240:243]
    v_mfma_f32_16x16x32_bf16 v[244:247], v[44:47], v[104:107], v[244:247]
    v_mfma_f32_16x16x32_bf16 v[252:255], v[44:47], v[108:111], v[252:255]
    v_mfma_f32_16x16x32_bf16 v[248:251], v[40:43], v[108:111], v[248:251]
    v_mfma_f32_16x16x32_bf16 v[236:239], v[36:39], v[108:111], v[236:239]
    v_mfma_f32_16x16x32_bf16 v[232:235], v[32:35], v[108:111], v[232:235]
    s_waitcnt lgkmcnt(0)
    v_mfma_f32_16x16x32_bf16 v[128:131], v[16:19], v[80:83], v[128:131]
    ds_read_b128 v[96:99], v74 offset:24576
    v_mfma_f32_16x16x32_bf16 v[132:135], v[20:23], v[80:83], v[132:135]
    ds_read_b128 v[100:103], v74 offset:26624
    v_mfma_f32_16x16x32_bf16 v[144:147], v[24:27], v[80:83], v[144:147]
    ds_read_b128 v[104:107], v74 offset:28672
    v_mfma_f32_16x16x32_bf16 v[148:151], v[28:31], v[80:83], v[148:151]
    ds_read_b128 v[108:111], v74 offset:30720
    v_mfma_f32_16x16x32_bf16 v[156:159], v[28:31], v[84:87], v[156:159]
    v_mfma_f32_16x16x32_bf16 v[152:155], v[24:27], v[84:87], v[152:155]
    v_mfma_f32_16x16x32_bf16 v[140:143], v[20:23], v[84:87], v[140:143]
    v_mfma_f32_16x16x32_bf16 v[136:139], v[16:19], v[84:87], v[136:139]
    v_mfma_f32_16x16x32_bf16 v[160:163], v[16:19], v[88:91], v[160:163]
    v_mfma_f32_16x16x32_bf16 v[164:167], v[20:23], v[88:91], v[164:167]
    v_mfma_f32_16x16x32_bf16 v[176:179], v[24:27], v[88:91], v[176:179]
    v_mfma_f32_16x16x32_bf16 v[180:183], v[28:31], v[88:91], v[180:183]
    v_mfma_f32_16x16x32_bf16 v[188:191], v[28:31], v[92:95], v[188:191]
    v_mfma_f32_16x16x32_bf16 v[184:187], v[24:27], v[92:95], v[184:187]
    v_mfma_f32_16x16x32_bf16 v[172:175], v[20:23], v[92:95], v[172:175]
    v_mfma_f32_16x16x32_bf16 v[168:171], v[16:19], v[92:95], v[168:171]
    s_waitcnt lgkmcnt(0)
    s_barrier
    ds_read_b64_tr_b16 v[32:33], v72 offset:49152
    ds_read_b64_tr_b16 v[34:35], v72 offset:51200
    ds_read_b128 v[80:83], v75 offset:16384
    ds_read_b64_tr_b16 v[36:37], v73 offset:49152
    ds_read_b64_tr_b16 v[38:39], v73 offset:51200
    ds_read_b64_tr_b16 v[40:41], v72 offset:50176
    v_mfma_f32_16x16x32_bf16 v[192:195], v[16:19], v[96:99], v[192:195]
    ds_read_b64_tr_b16 v[42:43], v72 offset:52224
    v_mfma_f32_16x16x32_bf16 v[196:199], v[20:23], v[96:99], v[196:199]
    ds_read_b64_tr_b16 v[44:45], v73 offset:50176
    v_mfma_f32_16x16x32_bf16 v[208:211], v[24:27], v[96:99], v[208:211]
    ds_read_b64_tr_b16 v[46:47], v73 offset:52224
    v_mfma_f32_16x16x32_bf16 v[212:215], v[28:31], v[96:99], v[212:215]
    ds_read_b128 v[84:87], v75 offset:18432
    v_mfma_f32_16x16x32_bf16 v[220:223], v[28:31], v[100:103], v[220:223]
    ds_read_b128 v[88:91], v75 offset:20480
    v_mfma_f32_16x16x32_bf16 v[216:219], v[24:27], v[100:103], v[216:219]
    ds_read_b128 v[92:95], v75 offset:22528
    v_mfma_f32_16x16x32_bf16 v[204:207], v[20:23], v[100:103], v[204:207]
    v_mfma_f32_16x16x32_bf16 v[200:203], v[16:19], v[100:103], v[200:203]
    v_mfma_f32_16x16x32_bf16 v[224:227], v[16:19], v[104:107], v[224:227]
    v_mfma_f32_16x16x32_bf16 v[228:231], v[20:23], v[104:107], v[228:231]
    v_mfma_f32_16x16x32_bf16 v[240:243], v[24:27], v[104:107], v[240:243]
    v_mfma_f32_16x16x32_bf16 v[244:247], v[28:31], v[104:107], v[244:247]
    v_mfma_f32_16x16x32_bf16 v[252:255], v[28:31], v[108:111], v[252:255]
    v_mfma_f32_16x16x32_bf16 v[248:251], v[24:27], v[108:111], v[248:251]
    v_mfma_f32_16x16x32_bf16 v[236:239], v[20:23], v[108:111], v[236:239]
    v_mfma_f32_16x16x32_bf16 v[232:235], v[16:19], v[108:111], v[232:235]
    s_waitcnt lgkmcnt(0)
    v_mfma_f32_16x16x32_bf16 v[128:131], v[32:35], v[80:83], v[128:131]
    ds_read_b128 v[96:99], v75 offset:24576
    v_mfma_f32_16x16x32_bf16 v[132:135], v[36:39], v[80:83], v[132:135]
    ds_read_b128 v[100:103], v75 offset:26624
    v_mfma_f32_16x16x32_bf16 v[144:147], v[40:43], v[80:83], v[144:147]
    ds_read_b128 v[104:107], v75 offset:28672
    v_mfma_f32_16x16x32_bf16 v[148:151], v[44:47], v[80:83], v[148:151]
    ds_read_b128 v[108:111], v75 offset:30720
    v_mfma_f32_16x16x32_bf16 v[156:159], v[44:47], v[84:87], v[156:159]
    v_mfma_f32_16x16x32_bf16 v[152:155], v[40:43], v[84:87], v[152:155]
    v_mfma_f32_16x16x32_bf16 v[140:143], v[36:39], v[84:87], v[140:143]
    v_mfma_f32_16x16x32_bf16 v[136:139], v[32:35], v[84:87], v[136:139]
    v_mfma_f32_16x16x32_bf16 v[160:163], v[32:35], v[88:91], v[160:163]
    v_mfma_f32_16x16x32_bf16 v[164:167], v[36:39], v[88:91], v[164:167]
    v_mfma_f32_16x16x32_bf16 v[176:179], v[40:43], v[88:91], v[176:179]
    v_mfma_f32_16x16x32_bf16 v[180:183], v[44:47], v[88:91], v[180:183]
    v_mfma_f32_16x16x32_bf16 v[188:191], v[44:47], v[92:95], v[188:191]
    v_mfma_f32_16x16x32_bf16 v[184:187], v[40:43], v[92:95], v[184:187]
    v_mfma_f32_16x16x32_bf16 v[172:175], v[36:39], v[92:95], v[172:175]
    v_mfma_f32_16x16x32_bf16 v[168:171], v[32:35], v[92:95], v[168:171]
    s_waitcnt lgkmcnt(0)
    s_barrier
    ds_read_b64_tr_b16 v[16:17], v72 offset:0
    ds_read_b64_tr_b16 v[18:19], v72 offset:2048
    ds_read_b128 v[80:83], v74 offset:0
    ds_read_b64_tr_b16 v[20:21], v73 offset:0
    ds_read_b64_tr_b16 v[22:23], v73 offset:2048
    ds_read_b64_tr_b16 v[24:25], v72 offset:1024
    v_mfma_f32_16x16x32_bf16 v[192:195], v[32:35], v[96:99], v[192:195]
    ds_read_b64_tr_b16 v[26:27], v72 offset:3072
    v_mfma_f32_16x16x32_bf16 v[196:199], v[36:39], v[96:99], v[196:199]
    ds_read_b64_tr_b16 v[28:29], v73 offset:1024
    v_mfma_f32_16x16x32_bf16 v[208:211], v[40:43], v[96:99], v[208:211]
    ds_read_b64_tr_b16 v[30:31], v73 offset:3072
    v_mfma_f32_16x16x32_bf16 v[212:215], v[44:47], v[96:99], v[212:215]
    ds_read_b128 v[84:87], v74 offset:2048
    v_mfma_f32_16x16x32_bf16 v[220:223], v[44:47], v[100:103], v[220:223]
    ds_read_b128 v[88:91], v74 offset:4096
    v_mfma_f32_16x16x32_bf16 v[216:219], v[40:43], v[100:103], v[216:219]
    ds_read_b128 v[92:95], v74 offset:6144
    v_mfma_f32_16x16x32_bf16 v[204:207], v[36:39], v[100:103], v[204:207]
    v_mfma_f32_16x16x32_bf16 v[200:203], v[32:35], v[100:103], v[200:203]
    v_mfma_f32_16x16x32_bf16 v[224:227], v[32:35], v[104:107], v[224:227]
    v_mfma_f32_16x16x32_bf16 v[228:231], v[36:39], v[104:107], v[228:231]
    v_mfma_f32_16x16x32_bf16 v[240:243], v[40:43], v[104:107], v[240:243]
    v_mfma_f32_16x16x32_bf16 v[244:247], v[44:47], v[104:107], v[244:247]
    v_mfma_f32_16x16x32_bf16 v[252:255], v[44:47], v[108:111], v[252:255]
    v_mfma_f32_16x16x32_bf16 v[248:251], v[40:43], v[108:111], v[248:251]
    s_add_u32 s30, s30, 1
    s_cmp_lt_u32 s30, 4
    v_mfma_f32_16x16x32_bf16 v[236:239], v[36:39], v[108:111], v[236:239]
    v_mfma_f32_16x16x32_bf16 v[232:235], v[32:35], v[108:111], v[232:235]
    s_cbranch_scc1 L_g1_loop
    v_pk_mul_f32 v[32:33], v[128:129], v[128:129]
    v_pk_mul_f32 v[34:35], v[130:131], v[130:131]
    v_pk_mul_f32 v[36:37], v[132:133], v[132:133]
    v_pk_mul_f32 v[38:39], v[134:135], v[134:135]
    v_pk_fma_f32 v[32:33], v[32:33], s[34:35], v[12:13]
    v_pk_fma_f32 v[34:35], v[34:35], s[34:35], v[12:13]
    v_pk_fma_f32 v[36:37], v[36:37], s[34:35], v[12:13]
    v_pk_fma_f32 v[38:39], v[38:39], s[34:35], v[12:13]
    v_pk_mul_f32 v[32:33], v[32:33], v[128:129]
    v_pk_mul_f32 v[34:35], v[34:35], v[130:131]
    v_pk_mul_f32 v[36:37], v[36:37], v[132:133]
    v_pk_mul_f32 v[38:39], v[38:39], v[134:135]
    v_pk_mul_f32 v[128:129], v[128:129], v[144:145]
    v_pk_mul_f32 v[130:131], v[130:131], v[146:147]
    v_exp_f32 v32, v32
    v_pk_mul_f32 v[132:133], v[132:133], v[148:149]
    v_pk_mul_f32 v[134:135], v[134:135], v[150:151]
    v_exp_f32 v33, v33
    v_pk_mul_f32 v[40:41], v[136:137], v[136:137]
    v_pk_mul_f32 v[42:43], v[138:139], v[138:139]
    v_exp_f32 v34, v34
    v_pk_add_f32 v[32:33], v[32:33], 1.0 op_sel_hi:[1,0]
    v_exp_f32 v35, v35
    v_pk_fma_f32 v[40:41], v[40:41], s[34:35], v[12:13]
    v_pk_fma_f32 v[42:43], v[42:43], s[34:35], v[12:13]
    v_rcp_f32 v32, v32
    v_pk_add_f32 v[34:35], v[34:35], 1.0 op_sel_hi:[1,0]
    v_pk_mul_f32 v[40:41], v[40:41], v[136:137]
    v_rcp_f32 v33, v33
    v_pk_mul_f32 v[42:43], v[42:43], v[138:139]
    v_pk_mul_f32 v[44:45], v[140:141], v[140:141]
    v_rcp_f32 v34, v34
    v_pk_mul_f32 v[128:129], v[128:129], v[32:33]
    v_rcp_f32 v35, v35
    v_pk_mul_f32 v[136:137], v[136:137], v[152:153]
    v_pk_mul_f32 v[138:139], v[138:139], v[154:155]
    v_exp_f32 v36, v36
    v_cvt_pk_bf16_f32 v96, v128, v129
    v_pk_mul_f32 v[130:131], v[130:131], v[34:35]
    v_exp_f32 v37, v37
    v_pk_fma_f32 v[44:45], v[44:45], s[34:35], v[12:13]
    v_pk_mul_f32 v[46:47], v[142:143], v[142:143]
    v_exp_f32 v38, v38
    v_cvt_pk_bf16_f32 v97, v130, v131
    v_exp_f32 v39, v39
    v_pk_add_f32 v[36:37], v[36:37], 1.0 op_sel_hi:[1,0]
    v_pk_mul_f32 v[44:45], v[44:45], v[140:141]
    v_exp_f32 v40, v40
    v_pk_add_f32 v[38:39], v[38:39], 1.0 op_sel_hi:[1,0]
    v_pk_fma_f32 v[46:47], v[46:47], s[34:35], v[12:13]
    v_rcp_f32 v36, v36
    v_pk_mul_f32 v[140:141], v[140:141], v[156:157]
    v_pk_mul_f32 v[112:113], v[160:161], v[160:161]
    v_rcp_f32 v37, v37
    v_pk_mul_f32 v[46:47], v[46:47], v[142:143]
    v_rcp_f32 v38, v38
    v_pk_fma_f32 v[112:113], v[112:113], s[34:35], v[12:13]
    v_pk_mul_f32 v[132:133], v[132:133], v[36:37]
    v_rcp_f32 v39, v39
    v_pk_mul_f32 v[142:143], v[142:143], v[158:159]
    v_pk_mul_f32 v[112:113], v[112:113], v[160:161]
    v_exp_f32 v41, v41
    v_cvt_pk_bf16_f32 v98, v132, v133
    v_pk_mul_f32 v[134:135], v[134:135], v[38:39]
    v_exp_f32 v42, v42
    v_pk_add_f32 v[40:41], v[40:41], 1.0 op_sel_hi:[1,0]
    v_exp_f32 v43, v43
    v_cvt_pk_bf16_f32 v99, v134, v135
    v_pk_mul_f32 v[160:161], v[160:161], v[176:177]
    v_rcp_f32 v40, v40
    v_pk_add_f32 v[42:43], v[42:43], 1.0 op_sel_hi:[1,0]
    buffer_store_dwordx4 v[96:99], v10, s[20:23], s43 offen offset:0 sc1
    v_rcp_f32 v41, v41
    v_pk_mul_f32 v[114:115], v[162:163], v[162:163]
    v_pk_mul_f32 v[116:117], v[164:165], v[164:165]
    v_rcp_f32 v42, v42
    v_pk_mul_f32 v[136:137], v[136:137], v[40:41]
    v_rcp_f32 v43, v43
    v_pk_fma_f32 v[114:115], v[114:115], s[34:35], v[12:13]
    v_pk_fma_f32 v[116:117], v[116:117], s[34:35], v[12:13]
    v_exp_f32 v44, v44
    v_cvt_pk_bf16_f32 v100, v136, v137
    v_pk_mul_f32 v[138:139], v[138:139], v[42:43]
    v_exp_f32 v45, v45
    v_pk_mul_f32 v[114:115], v[114:115], v[162:163]
    v_pk_mul_f32 v[116:117], v[116:117], v[164:165]
    v_exp_f32 v46, v46
    v_cvt_pk_bf16_f32 v101, v138, v139
    v_exp_f32 v47, v47
    v_pk_add_f32 v[44:45], v[44:45], 1.0 op_sel_hi:[1,0]
    v_pk_mul_f32 v[162:163], v[162:163], v[178:179]
    v_exp_f32 v112, v112
    v_pk_add_f32 v[46:47], v[46:47], 1.0 op_sel_hi:[1,0]
    v_pk_mul_f32 v[164:165], v[164:165], v[180:181]
    v_rcp_f32 v44, v44
    v_pk_mul_f32 v[118:119], v[166:167], v[166:167]
    v_pk_mul_f32 v[120:121], v[168:169], v[168:169]
    v_rcp_f32 v45, v45
    v_pk_mul_f32 v[122:123], v[170:171], v[170:171]
    v_rcp_f32 v46, v46
    v_pk_fma_f32 v[118:119], v[118:119], s[34:35], v[12:13]
    v_pk_mul_f32 v[140:141], v[140:141], v[44:45]
    v_rcp_f32 v47, v47
    v_pk_fma_f32 v[120:121], v[120:121], s[34:35], v[12:13]
    v_pk_mul_f32 v[118:119], v[118:119], v[166:167]
    v_exp_f32 v113, v113
    v_cvt_pk_bf16_f32 v102, v140, v141
    v_pk_mul_f32 v[142:143], v[142:143], v[46:47]
    v_exp_f32 v114, v114
    v_pk_add_f32 v[112:113], v[112:113], 1.0 op_sel_hi:[1,0]
    v_exp_f32 v115, v115
    v_cvt_pk_bf16_f32 v103, v142, v143
    v_pk_mul_f32 v[166:167], v[166:167], v[182:183]
    v_rcp_f32 v112, v112
    v_pk_add_f32 v[114:115], v[114:115], 1.0 op_sel_hi:[1,0]
    buffer_store_dwordx4 v[100:103], v10, s[20:23], s43 offen offset:256 sc1
    s_add_u32 s43, s43, 114688
    s_branch L_skip_ea0
L_pad_ea0:
    s_branch L_warm_ret1
L_skip_ea0:
    v_rcp_f32 v113, v113
    v_pk_mul_f32 v[120:121], v[120:121], v[168:169]
    v_pk_fma_f32 v[122:123], v[122:123], s[34:35], v[12:13]
    v_rcp_f32 v114, v114
    v_pk_mul_f32 v[160:161], v[160:161], v[112:113]
    v_rcp_f32 v115, v115
    v_pk_mul_f32 v[168:169], v[168:169], v[184:185]
    v_pk_mul_f32 v[122:123], v[122:123], v[170:171]
    v_exp_f32 v116, v116
    v_cvt_pk_bf16_f32 v104, v160, v161
    v_pk_mul_f32 v[162:163], v[162:163], v[114:115]
    v_exp_f32 v117, v117
    v_pk_mul_f32 v[170:171], v[170:171], v[186:187]
    v_pk_mul_f32 v[124:125], v[172:173], v[172:173]
    v_exp_f32 v118, v118
    v_cvt_pk_bf16_f32 v105, v162, v163
    v_exp_f32 v119, v119
    v_pk_add_f32 v[116:117], v[116:117], 1.0 op_sel_hi:[1,0]
    v_pk_fma_f32 v[124:125], v[124:125], s[34:35], v[12:13]
    v_exp_f32 v120, v120
    v_pk_add_f32 v[118:119], v[118:119], 1.0 op_sel_hi:[1,0]
    v_pk_mul_f32 v[126:127], v[174:175], v[174:175]
    v_rcp_f32 v116, v116
    v_pk_mul_f32 v[124:125], v[124:125], v[172:173]
    v_pk_mul_f32 v[32:33], v[192:193], v[192:193]
    v_rcp_f32 v117, v117
    v_pk_fma_f32 v[126:127], v[126:127], s[34:35], v[12:13]
    v_rcp_f32 v118, v118
    v_pk_mul_f32 v[172:173], v[172:173], v[188:189]
    v_pk_mul_f32 v[164:165], v[164:165], v[116:117]
    v_rcp_f32 v119, v119
    v_pk_mul_f32 v[126:127], v[126:127], v[174:175]
    v_pk_fma_f32 v[32:33], v[32:33], s[34:35], v[12:13]
    v_exp_f32 v121, v121
    v_cvt_pk_bf16_f32 v106, v164, v165
    v_pk_mul_f32 v[166:167], v[166:167], v[118:119]
    v_exp_f32 v122, v122
    v_pk_add_f32 v[120:121], v[120:121], 1.0 op_sel_hi:[1,0]
    v_exp_f32 v123, v123
    v_cvt_pk_bf16_f32 v107, v166, v167
    v_pk_mul_f32 v[174:175], v[174:175], v[190:191]
    v_rcp_f32 v120, v120
    v_pk_add_f32 v[122:123], v[122:123], 1.0 op_sel_hi:[1,0]
    buffer_store_dwordx4 v[104:107], v10, s[20:23], s43 offen offset:0 sc1
    v_rcp_f32 v121, v121
    v_pk_mul_f32 v[32:33], v[32:33], v[192:193]
    v_pk_mul_f32 v[34:35], v[194:195], v[194:195]
    v_rcp_f32 v122, v122
    v_pk_mul_f32 v[168:169], v[168:169], v[120:121]
    v_rcp_f32 v123, v123
    v_pk_mul_f32 v[192:193], v[192:193], v[208:209]
    v_pk_fma_f32 v[34:35], v[34:35], s[34:35], v[12:13]
    v_exp_f32 v124, v124
    v_cvt_pk_bf16_f32 v108, v168, v169
    v_pk_mul_f32 v[170:171], v[170:171], v[122:123]
    v_exp_f32 v125, v125
    v_pk_mul_f32 v[34:35], v[34:35], v[194:195]
    v_pk_mul_f32 v[36:37], v[196:197], v[196:197]
    v_exp_f32 v126, v126
    v_cvt_pk_bf16_f32 v109, v170, v171
    v_exp_f32 v127, v127
    v_pk_add_f32 v[124:125], v[124:125], 1.0 op_sel_hi:[1,0]
    v_pk_mul_f32 v[194:195], v[194:195], v[210:211]
    v_exp_f32 v32, v32
    v_pk_add_f32 v[126:127], v[126:127], 1.0 op_sel_hi:[1,0]
    v_pk_fma_f32 v[36:37], v[36:37], s[34:35], v[12:13]
    v_rcp_f32 v124, v124
    v_pk_mul_f32 v[38:39], v[198:199], v[198:199]
    v_pk_mul_f32 v[40:41], v[200:201], v[200:201]
    v_rcp_f32 v125, v125
    v_pk_mul_f32 v[36:37], v[36:37], v[196:197]
    v_rcp_f32 v126, v126
    v_pk_fma_f32 v[38:39], v[38:39], s[34:35], v[12:13]
    v_pk_mul_f32 v[172:173], v[172:173], v[124:125]
    v_rcp_f32 v127, v127
    v_pk_mul_f32 v[196:197], v[196:197], v[212:213]
    v_pk_mul_f32 v[38:39], v[38:39], v[198:199]
    v_exp_f32 v33, v33
    v_cvt_pk_bf16_f32 v110, v172, v173
    v_pk_mul_f32 v[174:175], v[174:175], v[126:127]
    v_exp_f32 v34, v34
    v_pk_add_f32 v[32:33], v[32:33], 1.0 op_sel_hi:[1,0]
    v_exp_f32 v35, v35
    v_cvt_pk_bf16_f32 v111, v174, v175
    v_pk_mul_f32 v[198:199], v[198:199], v[214:215]
    v_rcp_f32 v32, v32
    v_pk_add_f32 v[34:35], v[34:35], 1.0 op_sel_hi:[1,0]
    buffer_store_dwordx4 v[108:111], v10, s[20:23], s43 offen offset:256 sc1
    s_add_u32 s43, s43, 114688
    v_rcp_f32 v33, v33
    v_pk_fma_f32 v[40:41], v[40:41], s[34:35], v[12:13]
    v_pk_mul_f32 v[42:43], v[202:203], v[202:203]
    v_rcp_f32 v34, v34
    v_pk_mul_f32 v[192:193], v[192:193], v[32:33]
    v_rcp_f32 v35, v35
    v_pk_mul_f32 v[40:41], v[40:41], v[200:201]
    v_pk_fma_f32 v[42:43], v[42:43], s[34:35], v[12:13]
    v_exp_f32 v36, v36
    v_cvt_pk_bf16_f32 v96, v192, v193
    v_pk_mul_f32 v[194:195], v[194:195], v[34:35]
    v_exp_f32 v37, v37
    v_pk_mul_f32 v[200:201], v[200:201], v[216:217]
    v_pk_mul_f32 v[42:43], v[42:43], v[202:203]
    v_exp_f32 v38, v38
    v_cvt_pk_bf16_f32 v97, v194, v195
    v_exp_f32 v39, v39
    v_pk_add_f32 v[36:37], v[36:37], 1.0 op_sel_hi:[1,0]
    v_pk_mul_f32 v[202:203], v[202:203], v[218:219]
    v_exp_f32 v40, v40
    v_pk_add_f32 v[38:39], v[38:39], 1.0 op_sel_hi:[1,0]
    v_pk_mul_f32 v[44:45], v[204:205], v[204:205]
    v_rcp_f32 v36, v36
    v_pk_mul_f32 v[46:47], v[206:207], v[206:207]
    v_pk_mul_f32 v[112:113], v[224:225], v[224:225]
    v_rcp_f32 v37, v37
    v_pk_fma_f32 v[44:45], v[44:45], s[34:35], v[12:13]
    v_rcp_f32 v38, v38
    v_pk_fma_f32 v[46:47], v[46:47], s[34:35], v[12:13]
    v_pk_mul_f32 v[196:197], v[196:197], v[36:37]
    v_rcp_f32 v39, v39
    v_pk_mul_f32 v[44:45], v[44:45], v[204:205]
    v_pk_mul_f32 v[46:47], v[46:47], v[206:207]
    v_exp_f32 v41, v41
    v_cvt_pk_bf16_f32 v98, v196, v197
    v_pk_mul_f32 v[198:199], v[198:199], v[38:39]
    v_exp_f32 v42, v42
    v_pk_add_f32 v[40:41], v[40:41], 1.0 op_sel_hi:[1,0]
    v_exp_f32 v43, v43
    v_cvt_pk_bf16_f32 v99, v198, v199
    v_pk_mul_f32 v[204:205], v[204:205], v[220:221]
    v_rcp_f32 v40, v40
    v_pk_add_f32 v[42:43], v[42:43], 1.0 op_sel_hi:[1,0]
    buffer_store_dwordx4 v[96:99], v10, s[20:23], s43 offen offset:0 sc1
    s_branch L_skip_ea1
L_pad_ea1:
    s_branch L_warm_ret1
L_skip_ea1:
    v_rcp_f32 v41, v41
    v_pk_mul_f32 v[206:207], v[206:207], v[222:223]
    v_pk_fma_f32 v[112:113], v[112:113], s[34:35], v[12:13]
    v_rcp_f32 v42, v42
    v_pk_mul_f32 v[200:201], v[200:201], v[40:41]
    v_rcp_f32 v43, v43
    v_pk_mul_f32 v[112:113], v[112:113], v[224:225]
    v_pk_mul_f32 v[114:115], v[226:227], v[226:227]
    v_exp_f32 v44, v44
    v_cvt_pk_bf16_f32 v100, v200, v201
    v_pk_mul_f32 v[202:203], v[202:203], v[42:43]
    v_exp_f32 v45, v45
    v_pk_mul_f32 v[224:225], v[224:225], v[240:241]
    v_pk_fma_f32 v[114:115], v[114:115], s[34:35], v[12:13]
    v_exp_f32 v46, v46
    v_cvt_pk_bf16_f32 v101, v202, v203
    v_exp_f32 v47, v47
    v_pk_add_f32 v[44:45], v[44:45], 1.0 op_sel_hi:[1,0]
    v_pk_mul_f32 v[114:115], v[114:115], v[226:227]
    v_exp_f32 v112, v112
    v_pk_add_f32 v[46:47], v[46:47], 1.0 op_sel_hi:[1,0]
    v_pk_mul_f32 v[116:117], v[228:229], v[228:229]
    v_rcp_f32 v44, v44
    v_pk_mul_f32 v[226:227], v[226:227], v[242:243]
    v_pk_mul_f32 v[118:119], v[230:231], v[230:231]
    v_rcp_f32 v45, v45
    v_pk_fma_f32 v[116:117], v[116:117], s[34:35], v[12:13]
    v_rcp_f32 v46, v46
    v_pk_fma_f32 v[118:119], v[118:119], s[34:35], v[12:13]
    v_pk_mul_f32 v[204:205], v[204:205], v[44:45]
    v_rcp_f32 v47, v47
    v_pk_mul_f32 v[116:117], v[116:117], v[228:229]
    v_pk_mul_f32 v[118:119], v[118:119], v[230:231]
    v_exp_f32 v113, v113
    v_cvt_pk_bf16_f32 v102, v204, v205
    v_pk_mul_f32 v[206:207], v[206:207], v[46:47]
    v_exp_f32 v114, v114
    v_pk_add_f32 v[112:113], v[112:113], 1.0 op_sel_hi:[1,0]
    v_exp_f32 v115, v115
    v_cvt_pk_bf16_f32 v103, v206, v207
    v_pk_mul_f32 v[228:229], v[228:229], v[244:245]
    v_rcp_f32 v112, v112
    v_pk_add_f32 v[114:115], v[114:115], 1.0 op_sel_hi:[1,0]
    buffer_store_dwordx4 v[100:103], v10, s[20:23], s43 offen offset:256 sc1
    s_add_u32 s43, s43, 114688
    v_rcp_f32 v113, v113
    v_pk_mul_f32 v[230:231], v[230:231], v[246:247]
    v_pk_mul_f32 v[120:121], v[232:233], v[232:233]
    v_rcp_f32 v114, v114
    v_pk_mul_f32 v[224:225], v[224:225], v[112:113]
    v_rcp_f32 v115, v115
    v_pk_fma_f32 v[120:121], v[120:121], s[34:35], v[12:13]
    v_pk_mul_f32 v[122:123], v[234:235], v[234:235]
    v_exp_f32 v116, v116
    v_cvt_pk_bf16_f32 v104, v224, v225
    v_pk_mul_f32 v[226:227], v[226:227], v[114:115]
    v_exp_f32 v117, v117
    v_pk_mul_f32 v[120:121], v[120:121], v[232:233]
    v_pk_fma_f32 v[122:123], v[122:123], s[34:35], v[12:13]
    v_exp_f32 v118, v118
    v_cvt_pk_bf16_f32 v105, v226, v227
    v_exp_f32 v119, v119
    v_pk_add_f32 v[116:117], v[116:117], 1.0 op_sel_hi:[1,0]
    v_pk_mul_f32 v[232:233], v[232:233], v[248:249]
    v_exp_f32 v120, v120
    v_pk_add_f32 v[118:119], v[118:119], 1.0 op_sel_hi:[1,0]
    v_pk_mul_f32 v[122:123], v[122:123], v[234:235]
    v_rcp_f32 v116, v116
    v_pk_mul_f32 v[124:125], v[236:237], v[236:237]
    v_pk_mul_f32 v[126:127], v[238:239], v[238:239]
    v_rcp_f32 v117, v117
    v_pk_mul_f32 v[234:235], v[234:235], v[250:251]
    v_rcp_f32 v118, v118
    v_pk_fma_f32 v[124:125], v[124:125], s[34:35], v[12:13]
    v_pk_mul_f32 v[228:229], v[228:229], v[116:117]
    v_rcp_f32 v119, v119
    v_pk_fma_f32 v[126:127], v[126:127], s[34:35], v[12:13]
    v_pk_mul_f32 v[124:125], v[124:125], v[236:237]
    v_exp_f32 v121, v121
    v_cvt_pk_bf16_f32 v106, v228, v229
    v_pk_mul_f32 v[230:231], v[230:231], v[118:119]
    v_exp_f32 v122, v122
    v_pk_add_f32 v[120:121], v[120:121], 1.0 op_sel_hi:[1,0]
    v_exp_f32 v123, v123
    v_cvt_pk_bf16_f32 v107, v230, v231
    v_pk_mul_f32 v[236:237], v[236:237], v[252:253]
    v_rcp_f32 v120, v120
    v_pk_add_f32 v[122:123], v[122:123], 1.0 op_sel_hi:[1,0]
    buffer_store_dwordx4 v[104:107], v10, s[20:23], s43 offen offset:0 sc1
    v_rcp_f32 v121, v121
    v_pk_mul_f32 v[126:127], v[126:127], v[238:239]
    v_rcp_f32 v122, v122
    v_rcp_f32 v123, v123
    v_pk_mul_f32 v[232:233], v[232:233], v[120:121]
    v_exp_f32 v124, v124
    v_pk_mul_f32 v[238:239], v[238:239], v[254:255]
    v_pk_mul_f32 v[234:235], v[234:235], v[122:123]
    v_exp_f32 v125, v125
    v_cvt_pk_bf16_f32 v108, v232, v233
    v_exp_f32 v126, v126
    v_exp_f32 v127, v127
    v_cvt_pk_bf16_f32 v109, v234, v235
    v_pk_add_f32 v[124:125], v[124:125], 1.0 op_sel_hi:[1,0]
    v_pk_add_f32 v[126:127], v[126:127], 1.0 op_sel_hi:[1,0]
    v_rcp_f32 v124, v124
    v_rcp_f32 v125, v125
    v_rcp_f32 v126, v126
    v_rcp_f32 v127, v127
    v_pk_mul_f32 v[236:237], v[236:237], v[124:125]
    v_pk_mul_f32 v[238:239], v[238:239], v[126:127]
    v_cvt_pk_bf16_f32 v110, v236, v237
    v_cvt_pk_bf16_f32 v111, v238, v239
    s_nop 0
    buffer_store_dwordx4 v[108:111], v10, s[20:23], s43 offen offset:256 sc1
    s_lshr_b32 s6, s36, 1
    s_and_b32 s7, s36, 1
    s_mul_i32 s5, s6, 12928
    s_add_u32 s5, s5, 98304
    v_and_b32 v60, 15, v1
    v_lshrrev_b32 v61, 4, v1
    v_and_b32 v62, 1, v60
    v_xor_b32 v62, 1, v62
    v_mul_u32_u24 v62, 4160, v62
    v_and_b32 v63, 14, v60
    v_lshlrev_b32 v63, 1, v63
    v_sub_u32 v62, v62, v63
    v_lshl_add_u32 v62, v61, 4, v62
    s_lshl_b32 s4, s7, 8
    s_sub_u32 s4, s5, s4
    s_add_u32 s3, s4, 3356
    v_add_u32 v48, s3, v62
    v_subrev_u32 v49, 1024, v48
    v_subrev_u32 v50, 2048, v48
    v_subrev_u32 v51, 3072, v48
    v_lshlrev_b32 v52, 5, v60
    v_lshl_add_u32 v52, v61, 4, v52
    s_add_u32 s3, s4, 8608
    v_add_u32 v52, s3, v52
    v_lshlrev_b32 v53, 6, v60
    v_lshl_add_u32 v53, v61, 4, v53
    s_lshl_b32 s3, s36, 13
    s_add_u32 s3, s3, 124160
    v_add_u32 v53, s3, v53
    v_lshlrev_b32 v56, 4, v0
    v_add_u32 v57, 4096, v56
    v_add_u32 v54, 124160, v56
    v_mov_b32 v58, 161568
    v_and_b32 v62, 2, v61
    v_and_b32 v63, 1, v61
    v_lshl_or_b32 v62, v62, 2, v63
    v_xor_b32 v62, v62, v1
    v_lshl_add_u32 v53, v62, 4, s3
    v_and_b32 v62, 2, v1
    v_and_b32 v63, 1, v1
    v_lshl_or_b32 v62, v62, 2, v63
    v_lshrrev_b32 v63, 2, v1
    v_xor_b32 v62, v62, v63
    v_and_b32 v63, 3, v1
    v_lshl_add_u32 v62, v63, 4, v62
    s_lshl_b32 s3, s36, 10
    s_add_u32 s3, s3, 124160
    v_lshl_add_u32 v54, v62, 4, s3
    s_mov_b64 exec, 3
    s_waitcnt vmcnt(0)
    buffer_store_dword v14, v15, s[20:23], s49 offen sc1
    s_mov_b64 exec, -1
L_a_join:
    s_waitcnt lgkmcnt(0)
    s_barrier
    s_setprio 2
    ds_read2_b32 v[96:97], v48 offset0:176 offset1:177
    ds_read2_b32 v[98:99], v48 offset0:178 offset1:179
    ds_read_b128 v[128:131], v52 offset:192
    ds_read_b128 v[132:135], v52 offset:704
    ds_read_b128 v[136:139], v52 offset:1216
    ds_read_b128 v[140:143], v52 offset:1728
    ds_read_b128 v[144:147], v52 offset:2240
    ds_read_b128 v[148:151], v52 offset:2752
    ds_read_b128 v[152:155], v52 offset:3264
    ds_read_b128 v[156:159], v52 offset:3776
    ds_read2_b32 v[100:101], v48 offset0:48 offset1:49
    ds_read2_b32 v[102:103], v48 offset0:50 offset1:51
    ds_read2_b32 v[104:105], v49 offset0:176 offset1:177
    ds_read2_b32 v[106:107], v49 offset0:178 offset1:179
    ds_read2_b32 v[108:109], v49 offset0:48 offset1:49
    ds_read2_b32 v[110:111], v49 offset0:50 offset1:51
    ds_read2_b32 v[112:113], v50 offset0:176 offset1:177
    ds_read2_b32 v[114:115], v50 offset0:178 offset1:179
    ds_read2_b32 v[116:117], v50 offset0:48 offset1:49
    ds_read2_b32 v[118:119], v50 offset0:50 offset1:51
    ds_read2_b32 v[120:121], v51 offset0:176 offset1:177
    ds_read2_b32 v[122:123], v51 offset0:178 offset1:179
    ds_read2_b32 v[124:125], v51 offset0:48 offset1:49
    ds_read2_b32 v[126:127], v51 offset0:50 offset1:51
    s_waitcnt lgkmcnt(14)
    v_mfma_f32_16x16x32_bf16 v[16:19], v[96:99], v[128:131], 0
    v_mfma_f32_16x16x32_bf16 v[20:23], v[96:99], v[132:135], 0
    v_mfma_f32_16x16x32_bf16 v[24:27], v[96:99], v[136:139], 0
    v_mfma_f32_16x16x32_bf16 v[28:31], v[96:99], v[140:143], 0
    v_mfma_f32_16x16x32_bf16 v[32:35], v[96:99], v[144:147], 0
    v_mfma_f32_16x16x32_bf16 v[36:39], v[96:99], v[148:151], 0
    v_mfma_f32_16x16x32_bf16 v[40:43], v[96:99], v[152:155], 0
    v_mfma_f32_16x16x32_bf16 v[44:47], v[96:99], v[156:159], 0
    s_waitcnt lgkmcnt(0)
    v_mfma_f32_16x16x32_bf16 v[20:23], v[100:103], v[128:131], v[20:23]
    ds_read_b128 v[192:195], v52 offset:128
    v_mfma_f32_16x16x32_bf16 v[24:27], v[100:103], v[132:135], v[24:27]
    ds_read_b128 v[196:199], v52 offset:640
    v_mfma_f32_16x16x32_bf16 v[28:31], v[100:103], v[136:139], v[28:31]
    ds_read_b128 v[200:203], v52 offset:1152
    v_mfma_f32_16x16x32_bf16 v[32:35], v[100:103], v[140:143], v[32:35]
    ds_read_b128 v[204:207], v52 offset:1664
    v_mfma_f32_16x16x32_bf16 v[36:39], v[100:103], v[144:147], v[36:39]
    ds_read_b128 v[208:211], v52 offset:2176
    v_mfma_f32_16x16x32_bf16 v[40:43], v[100:103], v[148:151], v[40:43]
    ds_read_b128 v[212:215], v52 offset:2688
    v_mfma_f32_16x16x32_bf16 v[44:47], v[100:103], v[152:155], v[44:47]
    ds_read_b128 v[216:219], v52 offset:3200
    v_mfma_f32_16x16x32_bf16 v[24:27], v[104:107], v[128:131], v[24:27]
    ds_read_b128 v[220:223], v52 offset:3712
    v_mfma_f32_16x16x32_bf16 v[28:31], v[104:107], v[132:135], v[28:31]
    ds_read2_b32 v[160:161], v48 offset0:160 offset1:161
    v_mfma_f32_16x16x32_bf16 v[32:35], v[104:107], v[136:139], v[32:35]
    ds_read2_b32 v[162:163], v48 offset0:162 offset1:163
    v_mfma_f32_16x16x32_bf16 v[36:39], v[104:107], v[140:143], v[36:39]
    ds_read2_b32 v[164:165], v48 offset0:32 offset1:33
    v_mfma_f32_16x16x32_bf16 v[40:43], v[104:107], v[144:147], v[40:43]
    ds_read2_b32 v[166:167], v48 offset0:34 offset1:35
    v_mfma_f32_16x16x32_bf16 v[44:47], v[104:107], v[148:151], v[44:47]
    ds_read2_b32 v[168:169], v49 offset0:160 offset1:161
    v_mfma_f32_16x16x32_bf16 v[28:31], v[108:111], v[128:131], v[28:31]
    ds_read2_b32 v[170:171], v49 offset0:162 offset1:163
    v_mfma_f32_16x16x32_bf16 v[32:35], v[108:111], v[132:135], v[32:35]
    ds_read2_b32 v[172:173], v49 offset0:32 offset1:33
    v_mfma_f32_16x16x32_bf16 v[36:39], v[108:111], v[136:139], v[36:39]
    ds_read2_b32 v[174:175], v49 offset0:34 offset1:35
    v_mfma_f32_16x16x32_bf16 v[40:43], v[108:111], v[140:143], v[40:43]
    ds_read2_b32 v[176:177], v50 offset0:160 offset1:161
    v_mfma_f32_16x16x32_bf16 v[44:47], v[108:111], v[144:147], v[44:47]
    ds_read2_b32 v[178:179], v50 offset0:162 offset1:163
    v_mfma_f32_16x16x32_bf16 v[32:35], v[112:115], v[128:131], v[32:35]
    ds_read2_b32 v[180:181], v50 offset0:32 offset1:33
    v_mfma_f32_16x16x32_bf16 v[36:39], v[112:115], v[132:135], v[36:39]
    ds_read2_b32 v[182:183], v50 offset0:34 offset1:35
    v_mfma_f32_16x16x32_bf16 v[40:43], v[112:115], v[136:139], v[40:43]
    ds_read2_b32 v[184:185], v51 offset0:160 offset1:161
    v_mfma_f32_16x16x32_bf16 v[44:47], v[112:115], v[140:143], v[44:47]
    ds_read2_b32 v[186:187], v51 offset0:162 offset1:163
    v_mfma_f32_16x16x32_bf16 v[36:39], v[116:119], v[128:131], v[36:39]
    ds_read2_b32 v[188:189], v51 offset0:32 offset1:33
    v_mfma_f32_16x16x32_bf16 v[40:43], v[116:119], v[132:135], v[40:43]
    ds_read2_b32 v[190:191], v51 offset0:34 offset1:35
    v_mfma_f32_16x16x32_bf16 v[44:47], v[116:119], v[136:139], v[44:47]
    v_mfma_f32_16x16x32_bf16 v[40:43], v[120:123], v[128:131], v[40:43]
    v_mfma_f32_16x16x32_bf16 v[44:47], v[120:123], v[132:135], v[44:47]
    v_mfma_f32_16x16x32_bf16 v[44:47], v[124:127], v[128:131], v[44:47]
    s_branch L_skip_cv0
L_pad_cv0:
    s_branch L_warm_ret2
L_skip_cv0:
    s_waitcnt lgkmcnt(0)
    v_mfma_f32_16x16x32_bf16 v[16:19], v[160:163], v[192:195], v[16:19]
    ds_read_b128 v[128:131], v52 offset:64
    v_mfma_f32_16x16x32_bf16 v[20:23], v[160:163], v[196:199], v[20:23]
    ds_read_b128 v[132:135], v52 offset:576
    v_mfma_f32_16x16x32_bf16 v[24:27], v[160:163], v[200:203], v[24:27]
    ds_read_b128 v[136:139], v52 offset:1088
    v_mfma_f32_16x16x32_bf16 v[28:31], v[160:163], v[204:207], v[28:31]
    ds_read_b128 v[140:143], v52 offset:1600
    v_mfma_f32_16x16x32_bf16 v[32:35], v[160:163], v[208:211], v[32:35]
    ds_read_b128 v[144:147], v52 offset:2112
    v_mfma_f32_16x16x32_bf16 v[36:39], v[160:163], v[212:215], v[36:39]
    ds_read_b128 v[148:151], v52 offset:2624
    v_mfma_f32_16x16x32_bf16 v[40:43], v[160:163], v[216:219], v[40:43]
    ds_read_b128 v[152:155], v52 offset:3136
    v_mfma_f32_16x16x32_bf16 v[44:47], v[160:163], v[220:223], v[44:47]
    ds_read_b128 v[156:159], v52 offset:3648
    v_mfma_f32_16x16x32_bf16 v[20:23], v[164:167], v[192:195], v[20:23]
    ds_read2_b32 v[96:97], v48 offset0:144 offset1:145
    v_mfma_f32_16x16x32_bf16 v[24:27], v[164:167], v[196:199], v[24:27]
    ds_read2_b32 v[98:99], v48 offset0:146 offset1:147
    v_mfma_f32_16x16x32_bf16 v[28:31], v[164:167], v[200:203], v[28:31]
    ds_read2_b32 v[100:101], v48 offset0:16 offset1:17
    v_mfma_f32_16x16x32_bf16 v[32:35], v[164:167], v[204:207], v[32:35]
    ds_read2_b32 v[102:103], v48 offset0:18 offset1:19
    v_mfma_f32_16x16x32_bf16 v[36:39], v[164:167], v[208:211], v[36:39]
    ds_read2_b32 v[104:105], v49 offset0:144 offset1:145
    v_mfma_f32_16x16x32_bf16 v[40:43], v[164:167], v[212:215], v[40:43]
    ds_read2_b32 v[106:107], v49 offset0:146 offset1:147
    v_mfma_f32_16x16x32_bf16 v[44:47], v[164:167], v[216:219], v[44:47]
    ds_read2_b32 v[108:109], v49 offset0:16 offset1:17
    v_mfma_f32_16x16x32_bf16 v[24:27], v[168:171], v[192:195], v[24:27]
    ds_read2_b32 v[110:111], v49 offset0:18 offset1:19
    v_mfma_f32_16x16x32_bf16 v[28:31], v[168:171], v[196:199], v[28:31]
    ds_read2_b32 v[112:113], v50 offset0:144 offset1:145
    v_mfma_f32_16x16x32_bf16 v[32:35], v[168:171], v[200:203], v[32:35]
    ds_read2_b32 v[114:115], v50 offset0:146 offset1:147
    v_mfma_f32_16x16x32_bf16 v[36:39], v[168:171], v[204:207], v[36:39]
    ds_read2_b32 v[116:117], v50 offset0:16 offset1:17
    v_mfma_f32_16x16x32_bf16 v[40:43], v[168:171], v[208:211], v[40:43]
    ds_read2_b32 v[118:119], v50 offset0:18 offset1:19
    v_mfma_f32_16x16x32_bf16 v[44:47], v[168:171], v[212:215], v[44:47]
    ds_read2_b32 v[120:121], v51 offset0:144 offset1:145
    v_mfma_f32_16x16x32_bf16 v[28:31], v[172:175], v[192:195], v[28:31]
    ds_read2_b32 v[122:123], v51 offset0:146 offset1:147
    v_mfma_f32_16x16x32_bf16 v[32:35], v[172:175], v[196:199], v[32:35]
    ds_read2_b32 v[124:125], v51 offset0:16 offset1:17
    v_mfma_f32_16x16x32_bf16 v[36:39], v[172:175], v[200:203], v[36:39]
    ds_read2_b32 v[126:127], v51 offset0:18 offset1:19
    v_mfma_f32_16x16x32_bf16 v[40:43], v[172:175], v[204:207], v[40:43]
    v_mfma_f32_16x16x32_bf16 v[44:47], v[172:175], v[208:211], v[44:47]
    v_mfma_f32_16x16x32_bf16 v[32:35], v[176:179], v[192:195], v[32:35]
    v_mfma_f32_16x16x32_bf16 v[36:39], v[176:179], v[196:199], v[36:39]
    v_mfma_f32_16x16x32_bf16 v[40:43], v[176:179], v[200:203], v[40:43]
    v_mfma_f32_16x16x32_bf16 v[44:47], v[176:179], v[204:207], v[44:47]
    v_mfma_f32_16x16x32_bf16 v[36:39], v[180:183], v[192:195], v[36:39]
    v_mfma_f32_16x16x32_bf16 v[40:43], v[180:183], v[196:199], v[40:43]
    v_mfma_f32_16x16x32_bf16 v[44:47], v[180:183], v[200:203], v[44:47]
    v_mfma_f32_16x16x32_bf16 v[40:43], v[184:187], v[192:195], v[40:43]
    v_mfma_f32_16x16x32_bf16 v[44:47], v[184:187], v[196:199], v[44:47]
    v_mfma_f32_16x16x32_bf16 v[44:47], v[188:191], v[192:195], v[44:47]
    s_waitcnt lgkmcnt(0)
    v_mfma_f32_16x16x32_bf16 v[16:19], v[96:99], v[128:131], v[16:19]
    ds_read_b128 v[192:195], v52 offset:0
    v_mfma_f32_16x16x32_bf16 v[20:23], v[96:99], v[132:135], v[20:23]
    ds_read_b128 v[196:199], v52 offset:512
    v_mfma_f32_16x16x32_bf16 v[24:27], v[96:99], v[136:139], v[24:27]
    ds_read_b128 v[200:203], v52 offset:1024
    v_mfma_f32_16x16x32_bf16 v[28:31], v[96:99], v[140:143], v[28:31]
    ds_read_b128 v[204:207], v52 offset:1536
    v_mfma_f32_16x16x32_bf16 v[32:35], v[96:99], v[144:147], v[32:35]
    ds_read_b128 v[208:211], v52 offset:2048
    v_mfma_f32_16x16x32_bf16 v[36:39], v[96:99], v[148:151], v[36:39]
    ds_read_b128 v[212:215], v52 offset:2560
    v_mfma_f32_16x16x32_bf16 v[40:43], v[96:99], v[152:155], v[40:43]
    ds_read_b128 v[216:219], v52 offset:3072
    v_mfma_f32_16x16x32_bf16 v[44:47], v[96:99], v[156:159], v[44:47]
    ds_read_b128 v[220:223], v52 offset:3584
    v_mfma_f32_16x16x32_bf16 v[20:23], v[100:103], v[128:131], v[20:23]
    ds_read2_b32 v[160:161], v48 offset0:128 offset1:129
    v_mfma_f32_16x16x32_bf16 v[24:27], v[100:103], v[132:135], v[24:27]
    ds_read2_b32 v[162:163], v48 offset0:130 offset1:131
    v_mfma_f32_16x16x32_bf16 v[28:31], v[100:103], v[136:139], v[28:31]
    ds_read2_b32 v[164:165], v48 offset0:0 offset1:1
    v_mfma_f32_16x16x32_bf16 v[32:35], v[100:103], v[140:143], v[32:35]
    ds_read2_b32 v[166:167], v48 offset0:2 offset1:3
    v_mfma_f32_16x16x32_bf16 v[36:39], v[100:103], v[144:147], v[36:39]
    ds_read2_b32 v[168:169], v49 offset0:128 offset1:129
    v_mfma_f32_16x16x32_bf16 v[40:43], v[100:103], v[148:151], v[40:43]
    ds_read2_b32 v[170:171], v49 offset0:130 offset1:131
    v_mfma_f32_16x16x32_bf16 v[44:47], v[100:103], v[152:155], v[44:47]
    ds_read2_b32 v[172:173], v49 offset0:0 offset1:1
    v_mfma_f32_16x16x32_bf16 v[24:27], v[104:107], v[128:131], v[24:27]
    ds_read2_b32 v[174:175], v49 offset0:2 offset1:3
    v_mfma_f32_16x16x32_bf16 v[28:31], v[104:107], v[132:135], v[28:31]
    ds_read2_b32 v[176:177], v50 offset0:128 offset1:129
    v_mfma_f32_16x16x32_bf16 v[32:35], v[104:107], v[136:139], v[32:35]
    ds_read2_b32 v[178:179], v50 offset0:130 offset1:131
    v_mfma_f32_16x16x32_bf16 v[36:39], v[104:107], v[140:143], v[36:39]
    ds_read2_b32 v[180:181], v50 offset0:0 offset1:1
    v_mfma_f32_16x16x32_bf16 v[40:43], v[104:107], v[144:147], v[40:43]
    ds_read2_b32 v[182:183], v50 offset0:2 offset1:3
    v_mfma_f32_16x16x32_bf16 v[44:47], v[104:107], v[148:151], v[44:47]
    ds_read2_b32 v[184:185], v51 offset0:128 offset1:129
    v_mfma_f32_16x16x32_bf16 v[28:31], v[108:111], v[128:131], v[28:31]
    ds_read2_b32 v[186:187], v51 offset0:130 offset1:131
    v_mfma_f32_16x16x32_bf16 v[32:35], v[108:111], v[132:135], v[32:35]
    ds_read2_b32 v[188:189], v51 offset0:0 offset1:1
    v_mfma_f32_16x16x32_bf16 v[36:39], v[108:111], v[136:139], v[36:39]
    ds_read2_b32 v[190:191], v51 offset0:2 offset1:3
    v_mfma_f32_16x16x32_bf16 v[40:43], v[108:111], v[140:143], v[40:43]
    v_mfma_f32_16x16x32_bf16 v[44:47], v[108:111], v[144:147], v[44:47]
    v_mfma_f32_16x16x32_bf16 v[32:35], v[112:115], v[128:131], v[32:35]
    v_mfma_f32_16x16x32_bf16 v[36:39], v[112:115], v[132:135], v[36:39]
    v_mfma_f32_16x16x32_bf16 v[40:43], v[112:115], v[136:139], v[40:43]
    v_mfma_f32_16x16x32_bf16 v[44:47], v[112:115], v[140:143], v[44:47]
    v_mfma_f32_16x16x32_bf16 v[36:39], v[116:119], v[128:131], v[36:39]
    v_mfma_f32_16x16x32_bf16 v[40:43], v[116:119], v[132:135], v[40:43]
    v_mfma_f32_16x16x32_bf16 v[44:47], v[116:119], v[136:139], v[44:47]
    v_mfma_f32_16x16x32_bf16 v[40:43], v[120:123], v[128:131], v[40:43]
    v_mfma_f32_16x16x32_bf16 v[44:47], v[120:123], v[132:135], v[44:47]
    v_mfma_f32_16x16x32_bf16 v[44:47], v[124:127], v[128:131], v[44:47]
    s_branch L_skip_cv1
L_pad_cv1:
    s_branch L_warm_ret2
L_skip_cv1:
    s_waitcnt lgkmcnt(0)
    v_mfma_f32_16x16x32_bf16 v[16:19], v[160:163], v[192:195], v[16:19]
    v_mfma_f32_16x16x32_bf16 v[20:23], v[160:163], v[196:199], v[20:23]
    v_mfma_f32_16x16x32_bf16 v[20:23], v[164:167], v[192:195], v[20:23]
    v_mfma_f32_16x16x32_bf16 v[24:27], v[160:163], v[200:203], v[24:27]
    v_mfma_f32_16x16x32_bf16 v[24:27], v[164:167], v[196:199], v[24:27]
    v_mfma_f32_16x16x32_bf16 v[24:27], v[168:171], v[192:195], v[24:27]
    v_mfma_f32_16x16x32_bf16 v[28:31], v[160:163], v[204:207], v[28:31]
    v_mfma_f32_16x16x32_bf16 v[28:31], v[164:167], v[200:203], v[28:31]
    v_mfma_f32_16x16x32_bf16 v[28:31], v[168:171], v[196:199], v[28:31]
    v_mfma_f32_16x16x32_bf16 v[28:31], v[172:175], v[192:195], v[28:31]
    ds_write_b128 v53, v[16:19] offset:0
    v_mfma_f32_16x16x32_bf16 v[32:35], v[160:163], v[208:211], v[32:35]
    v_mfma_f32_16x16x32_bf16 v[32:35], v[164:167], v[204:207], v[32:35]
    v_mfma_f32_16x16x32_bf16 v[32:35], v[168:171], v[200:203], v[32:35]
    v_mfma_f32_16x16x32_bf16 v[32:35], v[172:175], v[196:199], v[32:35]
    v_mfma_f32_16x16x32_bf16 v[32:35], v[176:179], v[192:195], v[32:35]
    ds_write_b128 v53, v[20:23] offset:1024
    ds_write_b128 v53, v[24:27] offset:2048
    v_mfma_f32_16x16x32_bf16 v[36:39], v[160:163], v[212:215], v[36:39]
    v_mfma_f32_16x16x32_bf16 v[36:39], v[164:167], v[208:211], v[36:39]
    v_mfma_f32_16x16x32_bf16 v[36:39], v[168:171], v[204:207], v[36:39]
    v_mfma_f32_16x16x32_bf16 v[36:39], v[172:175], v[200:203], v[36:39]
    v_mfma_f32_16x16x32_bf16 v[36:39], v[176:179], v[196:199], v[36:39]
    v_mfma_f32_16x16x32_bf16 v[36:39], v[180:183], v[192:195], v[36:39]
    ds_write_b128 v53, v[28:31] offset:3072
    v_mfma_f32_16x16x32_bf16 v[40:43], v[160:163], v[216:219], v[40:43]
    v_mfma_f32_16x16x32_bf16 v[40:43], v[164:167], v[212:215], v[40:43]
    v_mfma_f32_16x16x32_bf16 v[40:43], v[168:171], v[208:211], v[40:43]
    v_mfma_f32_16x16x32_bf16 v[40:43], v[172:175], v[204:207], v[40:43]
    v_mfma_f32_16x16x32_bf16 v[40:43], v[176:179], v[200:203], v[40:43]
    v_mfma_f32_16x16x32_bf16 v[40:43], v[180:183], v[196:199], v[40:43]
    v_mfma_f32_16x16x32_bf16 v[40:43], v[184:187], v[192:195], v[40:43]
    ds_write_b128 v53, v[32:35] offset:4096
    v_mfma_f32_16x16x32_bf16 v[44:47], v[160:163], v[220:223], v[44:47]
    v_mfma_f32_16x16x32_bf16 v[44:47], v[164:167], v[216:219], v[44:47]
    v_mfma_f32_16x16x32_bf16 v[44:47], v[168:171], v[212:215], v[44:47]
    v_mfma_f32_16x16x32_bf16 v[44:47], v[172:175], v[208:211], v[44:47]
    v_mfma_f32_16x16x32_bf16 v[44:47], v[176:179], v[204:207], v[44:47]
    v_mfma_f32_16x16x32_bf16 v[44:47], v[180:183], v[200:203], v[44:47]
    v_mfma_f32_16x16x32_bf16 v[44:47], v[184:187], v[196:199], v[44:47]
    v_mfma_f32_16x16x32_bf16 v[44:47], v[188:191], v[192:195], v[44:47]
    ds_write_b128 v53, v[36:39] offset:5120
    ds_write_b128 v53, v[40:43] offset:6144
    s_nop 5
    ds_write_b128 v53, v[44:47] offset:7168
    s_mov_b64 exec, 1
    s_waitcnt lgkmcnt(0)
    ds_add_u32 v58, v14
L_cv_sync:
    ds_read_b32 v2, v58
    s_waitcnt lgkmcnt(0)
    v_cmp_gt_u32 vcc, 4, v2
    s_cbranch_vccz L_cv_go
    s_sub_u32 s42, s42, 1
    s_cmp_lt_i32 s42, 0
    s_cbranch_scc0 L_cv_sync
L_cv_go:
    s_mov_b64 exec, -1
    ds_read_b128 v[160:163], v54 offset:0
    ds_read_b128 v[164:167], v54 offset:8192
    ds_read_b128 v[168:171], v54 offset:16384
    ds_read_b128 v[172:175], v54 offset:24576
    ds_read_b128 v[176:179], v54 offset:4096
    ds_read_b128 v[180:183], v54 offset:12288
    ds_read_b128 v[184:187], v54 offset:20480
    ds_read_b128 v[188:191], v54 offset:28672
    s_waitcnt lgkmcnt(4)
    v_add_f32 v160, v160, v164
    v_add_f32 v168, v168, v172
    v_add_f32 v161, v161, v165
    v_add_f32 v169, v169, v173
    v_add_f32 v162, v162, v166
    v_add_f32 v170, v170, v174
    v_add_f32 v163, v163, v167
    v_add_f32 v171, v171, v175
    v_cvt_pk_bf16_f32 v96, v160, v168
    v_cvt_pk_bf16_f32 v97, v161, v169
    v_cvt_pk_bf16_f32 v98, v162, v170
    v_cvt_pk_bf16_f32 v99, v163, v171
    s_waitcnt lgkmcnt(0)
    v_add_f32 v176, v176, v180
    v_add_f32 v184, v184, v188
    v_add_f32 v177, v177, v181
    v_add_f32 v185, v185, v189
    v_add_f32 v178, v178, v182
    v_add_f32 v186, v186, v190
    v_add_f32 v179, v179, v183
    v_add_f32 v187, v187, v191
    v_cvt_pk_bf16_f32 v100, v176, v184
    v_cvt_pk_bf16_f32 v101, v177, v185
    v_cvt_pk_bf16_f32 v102, v178, v186
    v_cvt_pk_bf16_f32 v103, v179, v187
    buffer_store_dwordx4 v[96:99], v56, s[20:23], s50 offen sc1
    buffer_store_dwordx4 v[100:103], v57, s[20:23], s50 offen sc1
    s_mov_b64 exec, 1
    s_waitcnt vmcnt(0)
    buffer_store_dword v14, v15, s[20:23], s51 offen sc1
    s_endpgm
L_pad_rb:
    s_branch L_warm_ret0
L_role_b:
    s_mov_b32 s100, 1
    v_and_b32 v127, 127, v0
    v_lshlrev_b32 v127, 2, v127
    s_lshr_b32 s6, s36, 1
    s_mul_i32 s4, s6, 30096
    s_add_u32 s4, s4, 98304
    v_add_u32 v127, s4, v127
    s_mov_b32 s54, 0x3fb8aa3b
    s_mov_b32 s55, 0x32a57060
    s_mov_b32 s68, s56
    s_mov_b32 s69, s57
    s_mov_b32 s70, 1835008
    s_mov_b32 s71, 0x00020000
    s_and_b32 s67, s2, 7
    s_cmp_eq_u32 s67, 7
    s_cselect_b32 s67, 3, s67
    s_and_b32 s3, s39, 1
    s_mul_i32 s3, s3, 0
    s_add_u32 s67, s67, s3
    s_mul_i32 s3, s67, 37
    s_lshr_b32 s3, s3, 8
    s_mul_i32 s3, s3, 7
    s_sub_u32 s67, s67, s3
    s_lshl_b32 s67, s67, 2
    s_mov_b32 s42, 4194304
    s_lshl_b32 s3, s2, 2
    s_load_dword s48, s[78:79], s3
    s_waitcnt vmcnt(12)
    v_lshlrev_b32 v120, 16, v120
    v_lshlrev_b32 v16, 16, v121
    v_lshlrev_b32 v17, 16, v122
    v_mul_f32 v18, s54, v120
    v_fma_f32 v19, v120, s54, -v18
    v_fma_f32 v19, v120, s55, v19
    v_exp_f32 v18, v18
    v_mul_f32 v19, 0x3f317218, v19
    v_fmac_f32 v18, v18, v19
    v_cvt_pk_bf16_f32 v18, 0, v18
    v_mul_f32 v16, v18, v16
    v_mul_f32 v17, v18, v17
    v_mul_f32 v16, s54, v16
    v_mul_f32 v17, 0.15915494, v17
    v_mul_f32 v40, 0x43000000, v16
    v_mul_f32 v41, 0x43000000, v17
    v_exp_f32 v40, v40
    v_fract_f32 v41, v41
    v_cos_f32 v20, v41
    v_sin_f32 v21, v41
    v_mul_f32 v20, v40, v20
    v_mul_f32 v21, v40, v21
    v_mul_f32 v42, 0x40000000, v16
    v_mul_f32 v43, 0x40000000, v17
    v_exp_f32 v42, v42
    v_fract_f32 v43, v43
    v_cos_f32 v24, v43
    v_sin_f32 v25, v43
    v_mul_f32 v24, v42, v24
    v_mul_f32 v25, v42, v25
    v_mov_b32 v111, 0x3f80
    ds_write_b32 v127, v111 offset:8448
    v_pk_mul_f32 v[44:45], v[20:21], v[20:21] op_sel_hi:[0,1]
    v_pk_fma_f32 v[44:45], v[20:21], v[20:21], v[44:45] op_sel:[1,1,0] op_sel_hi:[1,0,1] neg_lo:[0,1,0]
    v_pk_mul_f32 v[28:29], v[24:25], v[24:25] op_sel_hi:[0,1]
    v_pk_fma_f32 v[28:29], v[24:25], v[24:25], v[28:29] op_sel:[1,1,0] op_sel_hi:[1,0,1] neg_lo:[0,1,0]
    v_pk_mul_f32 v[38:39], v[44:45], v[20:21] op_sel_hi:[0,1]
    v_pk_fma_f32 v[38:39], v[44:45], v[20:21], v[38:39] op_sel:[1,1,0] op_sel_hi:[1,0,1] neg_lo:[0,1,0]
    v_pk_mul_f32 v[32:33], v[28:29], v[24:25] op_sel_hi:[0,1]
    v_pk_fma_f32 v[32:33], v[28:29], v[24:25], v[32:33] op_sel:[1,1,0] op_sel_hi:[1,0,1] neg_lo:[0,1,0]
    v_pk_mul_f32 v[96:97], v[44:45], v[44:45] op_sel_hi:[0,1]
    v_pk_fma_f32 v[96:97], v[44:45], v[44:45], v[96:97] op_sel:[1,1,0] op_sel_hi:[1,0,1] neg_lo:[0,1,0]
    v_cvt_pk_bf16_f32 v108, v44, v45
    ds_write_b32 v127, v108 offset:16896
    v_pk_mul_f32 v[40:41], v[44:45], v[24:25] op_sel_hi:[0,1]
    v_pk_fma_f32 v[40:41], v[44:45], v[24:25], v[40:41] op_sel:[1,1,0] op_sel_hi:[1,0,1] neg_lo:[0,1,0]
    v_cvt_pk_bf16_f32 v109, v40, v41
    ds_write_b32 v127, v109 offset:17424
    v_pk_mul_f32 v[42:43], v[44:45], v[28:29] op_sel_hi:[0,1]
    v_pk_fma_f32 v[42:43], v[44:45], v[28:29], v[42:43] op_sel:[1,1,0] op_sel_hi:[1,0,1] neg_lo:[0,1,0]
    v_cvt_pk_bf16_f32 v110, v42, v43
    ds_write_b32 v127, v110 offset:17952
    v_pk_mul_f32 v[40:41], v[44:45], v[32:33] op_sel_hi:[0,1]
    v_pk_fma_f32 v[40:41], v[44:45], v[32:33], v[40:41] op_sel:[1,1,0] op_sel_hi:[1,0,1] neg_lo:[0,1,0]
    v_cvt_pk_bf16_f32 v111, v40, v41
    ds_write_b32 v127, v111 offset:18480
    v_pk_mul_f32 v[100:101], v[38:39], v[44:45] op_sel_hi:[0,1]
    v_pk_fma_f32 v[100:101], v[38:39], v[44:45], v[100:101] op_sel:[1,1,0] op_sel_hi:[1,0,1] neg_lo:[0,1,0]
    v_cvt_pk_bf16_f32 v108, v38, v39
    ds_write_b32 v127, v108 offset:19008
    s_branch L_skip_rb1
L_pad_rb1:
    s_branch L_warm_ret0
L_skip_rb1:
    s_add_u32 s46, s44, 128
    s_and_b32 s46, s46, 1023
    s_add_u32 s46, s46, s25
    s_add_u32 m0, s28, 8192
    s_add_u32 s41, s46, 4294901760
    buffer_load_dwordx4 v240, s[8:11], s41 offen lds
    buffer_load_dwordx4 v241, s[8:11], s41 offen offset:1024 lds
    s_add_u32 m0, s28, 16384
    s_add_u32 s41, s46, 0
    buffer_load_dwordx4 v240, s[8:11], s41 offen lds
    buffer_load_dwordx4 v241, s[8:11], s41 offen offset:1024 lds
    v_pk_mul_f32 v[42:43], v[38:39], v[24:25] op_sel_hi:[0,1]
    v_pk_fma_f32 v[42:43], v[38:39], v[24:25], v[42:43] op_sel:[1,1,0] op_sel_hi:[1,0,1] neg_lo:[0,1,0]
    v_cvt_pk_bf16_f32 v109, v42, v43
    ds_write_b32 v127, v109 offset:19536
    v_pk_mul_f32 v[40:41], v[38:39], v[28:29] op_sel_hi:[0,1]
    v_pk_fma_f32 v[40:41], v[38:39], v[28:29], v[40:41] op_sel:[1,1,0] op_sel_hi:[1,0,1] neg_lo:[0,1,0]
    v_cvt_pk_bf16_f32 v110, v40, v41
    ds_write_b32 v127, v110 offset:20064
    v_pk_mul_f32 v[42:43], v[38:39], v[32:33] op_sel_hi:[0,1]
    v_pk_fma_f32 v[42:43], v[38:39], v[32:33], v[42:43] op_sel:[1,1,0] op_sel_hi:[1,0,1] neg_lo:[0,1,0]
    v_cvt_pk_bf16_f32 v111, v42, v43
    ds_write_b32 v127, v111 offset:20592
    v_pk_mul_f32 v[98:99], v[96:97], v[44:45] op_sel_hi:[0,1]
    v_pk_fma_f32 v[98:99], v[96:97], v[44:45], v[98:99] op_sel:[1,1,0] op_sel_hi:[1,0,1] neg_lo:[0,1,0]
    v_cvt_pk_bf16_f32 v108, v96, v97
    ds_write_b32 v127, v108 offset:21120
    v_pk_mul_f32 v[40:41], v[96:97], v[28:29] op_sel_hi:[0,1]
    v_pk_fma_f32 v[40:41], v[96:97], v[28:29], v[40:41] op_sel:[1,1,0] op_sel_hi:[1,0,1] neg_lo:[0,1,0]
    v_cvt_pk_bf16_f32 v109, v40, v41
    ds_write_b32 v127, v109 offset:21648
    v_pk_mul_f32 v[102:103], v[100:101], v[44:45] op_sel_hi:[0,1]
    v_pk_fma_f32 v[102:103], v[100:101], v[44:45], v[102:103] op_sel:[1,1,0] op_sel_hi:[1,0,1] neg_lo:[0,1,0]
    v_cvt_pk_bf16_f32 v110, v100, v101
    ds_write_b32 v127, v110 offset:22176
    v_pk_mul_f32 v[42:43], v[100:101], v[28:29] op_sel_hi:[0,1]
    v_pk_fma_f32 v[42:43], v[100:101], v[28:29], v[42:43] op_sel:[1,1,0] op_sel_hi:[1,0,1] neg_lo:[0,1,0]
    v_cvt_pk_bf16_f32 v111, v42, v43
    ds_write_b32 v127, v111 offset:22704
    v_pk_mul_f32 v[96:97], v[98:99], v[44:45] op_sel_hi:[0,1]
    v_pk_fma_f32 v[96:97], v[98:99], v[44:45], v[96:97] op_sel:[1,1,0] op_sel_hi:[1,0,1] neg_lo:[0,1,0]
    v_cvt_pk_bf16_f32 v108, v98, v99
    ds_write_b32 v127, v108 offset:23232
    v_pk_mul_f32 v[40:41], v[98:99], v[28:29] op_sel_hi:[0,1]
    v_pk_fma_f32 v[40:41], v[98:99], v[28:29], v[40:41] op_sel:[1,1,0] op_sel_hi:[1,0,1] neg_lo:[0,1,0]
    v_cvt_pk_bf16_f32 v109, v40, v41
    ds_write_b32 v127, v109 offset:23760
    v_pk_mul_f32 v[100:101], v[102:103], v[44:45] op_sel_hi:[0,1]
    v_pk_fma_f32 v[100:101], v[102:103], v[44:45], v[100:101] op_sel:[1,1,0] op_sel_hi:[1,0,1] neg_lo:[0,1,0]
    v_cvt_pk_bf16_f32 v110, v102, v103
    ds_write_b32 v127, v110 offset:24288
    v_pk_mul_f32 v[42:43], v[102:103], v[28:29] op_sel_hi:[0,1]
    v_pk_fma_f32 v[42:43], v[102:103], v[28:29], v[42:43] op_sel:[1,1,0] op_sel_hi:[1,0,1] neg_lo:[0,1,0]
    v_cvt_pk_bf16_f32 v111, v42, v43
    ds_write_b32 v127, v111 offset:24816
    v_pk_mul_f32 v[98:99], v[96:97], v[44:45] op_sel_hi:[0,1]
    v_pk_fma_f32 v[98:99], v[96:97], v[44:45], v[98:99] op_sel:[1,1,0] op_sel_hi:[1,0,1] neg_lo:[0,1,0]
    v_cvt_pk_bf16_f32 v108, v96, v97
    ds_write_b32 v127, v108 offset:25344
    v_pk_mul_f32 v[102:103], v[100:101], v[44:45] op_sel_hi:[0,1]
    v_pk_fma_f32 v[102:103], v[100:101], v[44:45], v[102:103] op_sel:[1,1,0] op_sel_hi:[1,0,1] neg_lo:[0,1,0]
    v_cvt_pk_bf16_f32 v109, v100, v101
    ds_write_b32 v127, v109 offset:25872
    v_pk_mul_f32 v[96:97], v[98:99], v[44:45] op_sel_hi:[0,1]
    v_pk_fma_f32 v[96:97], v[98:99], v[44:45], v[96:97] op_sel:[1,1,0] op_sel_hi:[1,0,1] neg_lo:[0,1,0]
    v_cvt_pk_bf16_f32 v110, v98, v99
    ds_write_b32 v127, v110 offset:26400
    v_pk_mul_f32 v[100:101], v[102:103], v[44:45] op_sel_hi:[0,1]
    v_pk_fma_f32 v[100:101], v[102:103], v[44:45], v[100:101] op_sel:[1,1,0] op_sel_hi:[1,0,1] neg_lo:[0,1,0]
    v_cvt_pk_bf16_f32 v111, v102, v103
    ds_write_b32 v127, v111 offset:26928
    v_pk_mul_f32 v[98:99], v[96:97], v[44:45] op_sel_hi:[0,1]
    v_pk_fma_f32 v[98:99], v[96:97], v[44:45], v[98:99] op_sel:[1,1,0] op_sel_hi:[1,0,1] neg_lo:[0,1,0]
    v_cvt_pk_bf16_f32 v108, v96, v97
    ds_write_b32 v127, v108 offset:27456
    v_pk_mul_f32 v[102:103], v[100:101], v[44:45] op_sel_hi:[0,1]
    v_pk_fma_f32 v[102:103], v[100:101], v[44:45], v[102:103] op_sel:[1,1,0] op_sel_hi:[1,0,1] neg_lo:[0,1,0]
    v_cvt_pk_bf16_f32 v109, v100, v101
    ds_write_b32 v127, v109 offset:27984
    v_pk_mul_f32 v[96:97], v[98:99], v[44:45] op_sel_hi:[0,1]
    v_pk_fma_f32 v[96:97], v[98:99], v[44:45], v[96:97] op_sel:[1,1,0] op_sel_hi:[1,0,1] neg_lo:[0,1,0]
    v_cvt_pk_bf16_f32 v110, v98, v99
    ds_write_b32 v127, v110 offset:28512
    v_cvt_pk_bf16_f32 v111, v102, v103
    ds_write_b32 v127, v111 offset:29040
    v_cvt_pk_bf16_f32 v108, v96, v97
    ds_write_b32 v127, v108 offset:29568
    s_waitcnt vmcnt(8) lgkmcnt(0)
    s_barrier
    s_add_u32 s46, s45, 2
    s_and_b32 s46, s46, 15
    s_mul_i32 s46, s46, 114688
    s_add_u32 s46, s46, s26
    s_add_u32 m0, s27, 24576
    s_add_u32 s41, s46, 4294909952
    buffer_load_dwordx4 v242, s[12:15], s41 offen lds
    buffer_load_dwordx4 v242, s[16:19], s41 offen offset:1024 lds
    s_add_u32 m0, s27, 32768
    s_add_u32 s41, s46, 0
    buffer_load_dwordx4 v242, s[12:15], s41 offen lds
    buffer_load_dwordx4 v242, s[16:19], s41 offen offset:1024 lds
    s_waitcnt vmcnt(8) lgkmcnt(0)
    s_barrier
    s_add_u32 s46, s45, 3
    s_and_b32 s46, s46, 15
    s_mul_i32 s46, s46, 114688
    s_add_u32 s46, s46, s26
    s_add_u32 m0, s27, 40960
    s_add_u32 s41, s46, 4294909952
    buffer_load_dwordx4 v242, s[12:15], s41 offen lds
    s_lshr_b32 s6, s36, 1
    buffer_load_dwordx4 v242, s[16:19], s41 offen offset:1024 lds
    s_and_b32 s7, s36, 1
    s_mul_i32 s4, s6, 30096
    s_add_u32 m0, s27, 49152
    s_add_u32 s41, s46, 0
    buffer_load_dwordx4 v242, s[12:15], s41 offen lds
    s_add_u32 s4, s4, 98304
    v_and_b32 v16, 15, v1
    buffer_load_dwordx4 v242, s[16:19], s41 offen offset:1024 lds
    v_lshrrev_b32 v17, 4, v1
    v_mul_u32_u24 v219, 528, v16
    s_add_u32 s46, s45, 4
    s_and_b32 s46, s46, 15
    s_mul_i32 s46, s46, 114688
    s_add_u32 s46, s46, s26
    s_add_u32 m0, s27, 4294959104
    s_add_u32 s41, s46, 4294909952
    buffer_load_dwordx4 v242, s[12:15], s41 offen lds
    v_lshl_add_u32 v219, v17, 4, v219
    buffer_load_dwordx4 v242, s[16:19], s41 offen offset:1024 lds
    v_add_u32 v219, s4, v219
    s_mul_i32 s4, s7, 8448
    s_add_u32 m0, s27, 0
    s_add_u32 s41, s46, 0
    buffer_load_dwordx4 v242, s[12:15], s41 offen lds
    v_add_u32 v220, s4, v219
    ds_read_b128 v[48:51], v219 offset:0
    buffer_load_dwordx4 v242, s[16:19], s41 offen offset:1024 lds
    s_lshl_b32 s3, s6, 1
    s_add_u32 s3, s3, 158496
    s_waitcnt vmcnt(8) lgkmcnt(0)
    s_barrier
    s_add_u32 s46, s44, 256
    s_and_b32 s46, s46, 1023
    s_add_u32 s46, s46, s25
    s_add_u32 m0, s28, 4294959104
    s_add_u32 s41, s46, 4294901760
    buffer_load_dwordx4 v240, s[8:11], s41 offen lds
    ds_read_b128 v[52:55], v220 offset:8448
    v_lshrrev_b32 v18, 1, v17
    buffer_load_dwordx4 v241, s[8:11], s41 offen offset:1024 lds
    v_and_b32 v19, 1, v17
    ds_read_b128 v[56:59], v219 offset:25344
    v_lshlrev_b32 v24, 7, v18
    s_add_u32 m0, s28, 0
    s_add_u32 s41, s46, 0
    buffer_load_dwordx4 v240, s[8:11], s41 offen lds
    v_lshl_add_u32 v24, v19, 2, v24
    ds_read_b128 v[60:63], v219 offset:64
    buffer_load_dwordx4 v241, s[8:11], s41 offen offset:1024 lds
    v_lshl_add_u32 v24, v16, 3, v24
    v_lshlrev_b32 v25, 6, v17
    ds_read_b128 v[64:67], v220 offset:8512
    s_add_u32 s46, s45, 5
    s_and_b32 s46, s46, 15
    s_mul_i32 s46, s46, 114688
    s_add_u32 s46, s46, s26
    s_add_u32 m0, s27, 8192
    s_add_u32 s41, s46, 4294909952
    buffer_load_dwordx4 v242, s[12:15], s41 offen lds
    v_add_u32 v25, 256, v25
    v_lshl_add_u32 v26, v16, 2, v25
    buffer_load_dwordx4 v242, s[16:19], s41 offen offset:1024 lds
    ds_read_b128 v[68:71], v219 offset:25408
    v_lshl_add_u32 v27, v16, 1, v25
    v_cmp_gt_u32 vcc, 2, v17
    s_waitcnt vmcnt(10) lgkmcnt(0)
    s_barrier
    s_add_u32 m0, s27, 16384
    s_add_u32 s41, s46, 0
    buffer_load_dwordx4 v242, s[12:15], s41 offen lds
    ds_read_b128 v[72:75], v219 offset:128
    v_mov_b32 v28, 32
    buffer_load_dwordx4 v242, s[16:19], s41 offen offset:1024 lds
    v_lshl_add_u32 v25, v17, 6, v16
    ds_read_b128 v[76:79], v220 offset:8576
    v_cndmask_b32 v26, v27, v26, vcc
    s_add_u32 s46, s45, 6
    s_and_b32 s46, s46, 15
    s_mul_i32 s46, s46, 114688
    s_add_u32 s46, s46, s26
    s_add_u32 m0, s27, 24576
    s_add_u32 s41, s46, 4294909952
    buffer_load_dwordx4 v242, s[12:15], s41 offen lds
    v_cndmask_b32 v28, v28, 2, vcc
    ds_read_b128 v[80:83], v219 offset:25472
    buffer_load_dwordx4 v242, s[16:19], s41 offen offset:1024 lds
    s_cmp_eq_u32 s7, 0
    s_cselect_b64 vcc, -1, 0
    ds_read_b128 v[84:87], v219 offset:192
    s_add_u32 m0, s27, 32768
    s_add_u32 s41, s46, 0
    buffer_load_dwordx4 v242, s[12:15], s41 offen lds
    v_lshl_add_u32 v223, v25, 2, s3
    v_cndmask_b32 v26, v26, v24, vcc
    buffer_load_dwordx4 v242, s[16:19], s41 offen offset:1024 lds
    ds_read_b128 v[88:91], v220 offset:8640
    v_cndmask_b32 v28, v28, 2, vcc
    v_add_u32 v28, v26, v28
    s_waitcnt vmcnt(8) lgkmcnt(0)
    s_barrier
    s_add_u32 s46, s44, 384
    s_and_b32 s46, s46, 1023
    s_add_u32 s46, s46, s25
    s_add_u32 m0, s28, 8192
    s_add_u32 s41, s46, 4294901760
    buffer_load_dwordx4 v240, s[8:11], s41 offen lds
    ds_read_b128 v[92:95], v219 offset:25536
    v_lshl_add_u32 v221, v26, 2, s3
    buffer_load_dwordx4 v241, s[8:11], s41 offen offset:1024 lds
    v_lshl_add_u32 v222, v28, 2, s3
    ds_read_b128 v[96:99], v219 offset:256
    v_lshrrev_b32 v16, 4, v1
    s_add_u32 m0, s28, 16384
    s_add_u32 s41, s46, 0
    buffer_load_dwordx4 v240, s[8:11], s41 offen lds
    v_and_b32 v16, 1, v16
    ds_read_b128 v[100:103], v220 offset:8704
    buffer_load_dwordx4 v241, s[8:11], s41 offen offset:1024 lds
    v_lshlrev_b32 v16, 2, v16
    v_and_b32 v17, 7, v1
    ds_read_b128 v[104:107], v219 offset:25600
    s_add_u32 s46, s45, 7
    s_and_b32 s46, s46, 15
    s_mul_i32 s46, s46, 114688
    s_add_u32 s46, s46, s26
    s_add_u32 m0, s27, 40960
    s_add_u32 s41, s46, 4294909952
    buffer_load_dwordx4 v242, s[12:15], s41 offen lds
    v_xor_b32 v16, v16, v17
    v_lshrrev_b32 v17, 3, v1
    buffer_load_dwordx4 v242, s[16:19], s41 offen offset:1024 lds
    ds_read_b128 v[108:111], v219 offset:320
    v_lshlrev_b32 v17, 10, v17
    v_lshl_add_u32 v248, v16, 4, v17
    s_branch L_skip_rb2
L_pad_rb2:
    s_branch L_warm_ret1
L_skip_rb2:
    s_waitcnt vmcnt(10) lgkmcnt(0)
    s_barrier
    s_add_u32 m0, s27, 49152
    s_add_u32 s41, s46, 0
    buffer_load_dwordx4 v242, s[12:15], s41 offen lds
    ds_read_b128 v[112:115], v220 offset:8768
    v_add_u32 v249, 15360, v248
    buffer_load_dwordx4 v242, s[16:19], s41 offen offset:1024 lds
    s_lshl_b32 s64, s36, 12
    ds_read_b128 v[116:119], v219 offset:25664
    s_mul_i32 s66, s36, 28
    s_add_u32 s46, s45, 8
    s_and_b32 s46, s46, 15
    s_mul_i32 s46, s46, 114688
    s_add_u32 s46, s46, s26
    s_add_u32 m0, s27, 4294959104
    s_add_u32 s41, s46, 4294909952
    buffer_load_dwordx4 v242, s[12:15], s41 offen lds
    s_add_u32 s66, s66, s67
    ds_read_b128 v[120:123], v219 offset:384
    buffer_load_dwordx4 v242, s[16:19], s41 offen offset:1024 lds
    s_lshl_b32 s3, s66, 10
    s_lshl_b32 s66, s66, 14
    ds_read_b128 v[124:127], v220 offset:8832
    s_add_u32 m0, s27, 0
    s_add_u32 s41, s46, 0
    buffer_load_dwordx4 v242, s[12:15], s41 offen lds
    s_lshl_b32 s4, s39, 7
    s_add_u32 s66, s66, s4
    buffer_load_dwordx4 v242, s[16:19], s41 offen offset:1024 lds
    ds_read_b128 v[128:131], v219 offset:25728
    s_and_b32 s6, s36, 1
    s_lshr_b32 s7, s36, 1
    s_waitcnt vmcnt(8) lgkmcnt(0)
    s_barrier
    s_add_u32 s46, s44, 512
    s_and_b32 s46, s46, 1023
    s_add_u32 s46, s46, s25
    s_add_u32 m0, s28, 4294959104
    s_add_u32 s41, s46, 4294901760
    buffer_load_dwordx4 v240, s[8:11], s41 offen lds
    ds_read_b128 v[132:135], v219 offset:448
    s_lshl_b32 s50, s38, 1
    buffer_load_dwordx4 v241, s[8:11], s41 offen offset:1024 lds
    s_add_u32 s50, s50, s6
    ds_read_b128 v[136:139], v220 offset:8896
    s_lshl_b32 s51, s39, 1
    s_add_u32 m0, s28, 0
    s_add_u32 s41, s46, 0
    buffer_load_dwordx4 v240, s[8:11], s41 offen lds
    s_add_u32 s51, s51, s7
    ds_read_b128 v[140:143], v219 offset:25792
    buffer_load_dwordx4 v241, s[8:11], s41 offen offset:1024 lds
    s_mul_i32 s52, s50, 114688
    s_xor_b32 s4, s50, 1
    s_mul_i32 s53, s4, 114688
    s_add_u32 s46, s45, 9
    s_and_b32 s46, s46, 15
    s_mul_i32 s46, s46, 114688
    s_add_u32 s46, s46, s26
    s_add_u32 m0, s27, 8192
    s_add_u32 s41, s46, 4294909952
    buffer_load_dwordx4 v242, s[12:15], s41 offen lds
    s_add_u32 s52, s52, s3
    s_add_u32 s53, s53, s3
    buffer_load_dwordx4 v242, s[16:19], s41 offen offset:1024 lds
    v_and_b32 v17, 16, v1
    v_lshlrev_b32 v18, 1, v17
    v_and_b32 v17, 1, v1
    s_cmp_eq_u32 s24, 4
    s_cbranch_scc0 L_noinit
    global_load_dword v250, v251, s[62:63] sc1
L_noinit:
    s_waitcnt vmcnt(10) lgkmcnt(0)
    s_barrier
    s_add_u32 m0, s27, 16384
    s_add_u32 s41, s46, 0
    buffer_load_dwordx4 v242, s[12:15], s41 offen lds
    v_lshl_add_u32 v18, v17, 4, v18
    v_and_b32 v17, 2, v1
    buffer_load_dwordx4 v242, s[16:19], s41 offen offset:1024 lds
    v_lshl_add_u32 v18, v17, 2, v18
    v_lshrrev_b32 v16, 2, v1
    v_and_b32 v16, 3, v16
    s_add_u32 s46, s45, 10
    s_and_b32 s46, s46, 15
    s_mul_i32 s46, s46, 114688
    s_add_u32 s46, s46, s26
    s_add_u32 m0, s27, 24576
    s_add_u32 s41, s46, 4294909952
    buffer_load_dwordx4 v242, s[12:15], s41 offen lds
    v_lshrrev_b32 v17, 5, v1
    v_lshl_add_u32 v19, v17, 2, v16
    buffer_load_dwordx4 v242, s[16:19], s41 offen offset:1024 lds
    v_lshl_add_u32 v8, v19, 7, v18
    v_lshrrev_b32 v16, 1, v16
    v_xor_b32 v16, s7, v16
    s_add_u32 m0, s27, 32768
    s_add_u32 s41, s46, 0
    buffer_load_dwordx4 v242, s[12:15], s41 offen lds
    v_lshl_add_u32 v8, v16, 6, v8
    v_add_u32 v8, s64, v8
    buffer_load_dwordx4 v242, s[16:19], s41 offen offset:1024 lds
    v_xor_b32 v9, 64, v8
    v_add_u32 v10, 0x10000, v8
    v_add_u32 v11, 0x10000, v9
    s_waitcnt vmcnt(8) lgkmcnt(0)
    s_barrier
    s_add_u32 s46, s44, 640
    s_and_b32 s46, s46, 1023
    s_add_u32 s46, s46, s25
    s_add_u32 m0, s28, 8192
    s_add_u32 s41, s46, 4294901760
    buffer_load_dwordx4 v240, s[8:11], s41 offen lds
    v_add_u32 v12, 124160, v8
    buffer_load_dwordx4 v241, s[8:11], s41 offen offset:1024 lds
    v_add_u32 v13, 124160, v9
    v_lshlrev_b32 v5, 7, v1
    s_add_u32 m0, s28, 16384
    s_add_u32 s41, s46, 0
    buffer_load_dwordx4 v240, s[8:11], s41 offen lds
    s_lshl_b32 s65, s38, 2
    s_add_u32 s65, s65, s36
    buffer_load_dwordx4 v241, s[8:11], s41 offen offset:1024 lds
    s_mul_i32 s65, s65, 1792
    s_add_u32 s65, s65, 11567104
    s_add_u32 s46, s45, 11
    s_and_b32 s46, s46, 15
    s_mul_i32 s46, s46, 114688
    s_add_u32 s46, s46, s26
    s_add_u32 m0, s27, 40960
    s_add_u32 s41, s46, 4294909952
    buffer_load_dwordx4 v242, s[12:15], s41 offen lds
    v_lshlrev_b32 v6, 4, v1
    s_lshl_b32 s3, s48, 16
    buffer_load_dwordx4 v242, s[16:19], s41 offen offset:1024 lds
    s_and_b32 s4, s48, 0xffff0000
    s_cmp_lt_u32 s36, 2
    s_cselect_b32 s3, s3, s4
    s_add_u32 m0, s64, 124160
    s_cmp_ge_u32 s67, 4
    s_cselect_b32 s47, 458752, 0
    s_add_u32 s41, s66, 393216
    s_sub_u32 s41, s41, s47
    buffer_load_dwordx4 v248, s[68:71], s41 offen lds
    s_and_b32 s4, s36, 1
    buffer_load_dwordx4 v249, s[68:71], s41 offen offset:1024 lds
    s_cmp_eq_u32 s4, 0
    s_cselect_b32 s3, s3, 0
    s_waitcnt vmcnt(12) lgkmcnt(0)
    s_barrier
    s_add_u32 m0, s27, 49152
    s_add_u32 s41, s46, 0
    buffer_load_dwordx4 v242, s[12:15], s41 offen lds
    v_mov_b32 v232, 0
    buffer_load_dwordx4 v242, s[16:19], s41 offen offset:1024 lds
    v_writelane_b32 v232, s3, 0
    v_mov_b32 v233, 161572
    s_add_u32 s46, s45, 12
    s_and_b32 s46, s46, 15
    s_mul_i32 s46, s46, 114688
    s_add_u32 s46, s46, s26
    s_add_u32 m0, s27, 4294959104
    s_add_u32 s41, s46, 4294909952
    buffer_load_dwordx4 v242, s[12:15], s41 offen lds
    v_and_b32 v32, 255, v0
    v_lshrrev_b32 v33, 3, v32
    buffer_load_dwordx4 v242, s[16:19], s41 offen offset:1024 lds
    v_lshlrev_b32 v217, 10, v33
    v_and_b32 v26, 7, v32
    s_add_u32 m0, s27, 0
    s_add_u32 s41, s46, 0
    buffer_load_dwordx4 v242, s[12:15], s41 offen lds
    v_lshl_add_u32 v217, v26, 4, v217
    buffer_load_dwordx4 v242, s[16:19], s41 offen offset:1024 lds
    v_xor_b32 v26, s2, v33
    v_and_b32 v26, 7, v26
    s_add_u32 m0, s64, 126208
    s_cmp_ge_u32 s67, 3
    s_cselect_b32 s47, 458752, 0
    s_add_u32 s41, s66, 401408
    s_sub_u32 s41, s41, s47
    buffer_load_dwordx4 v248, s[68:71], s41 offen lds
    v_lshl_add_u32 v217, v26, 7, v217
    v_add_u32 v218, 32768, v217
    buffer_load_dwordx4 v249, s[68:71], s41 offen offset:1024 lds
    s_lshr_b32 s29, s2, 3
    s_lshl_b32 s29, s29, 16
    s_branch L_skip_g1b
L_pad_g1b:
    s_branch L_warm_ret1
L_skip_g1b:
    s_waitcnt vmcnt(12) lgkmcnt(0)
    s_barrier
    s_add_u32 s46, s44, 768
    s_and_b32 s46, s46, 1023
    s_add_u32 s46, s46, s25
    s_add_u32 m0, s28, 4294959104
    s_add_u32 s41, s46, 4294901760
    buffer_load_dwordx4 v240, s[8:11], s41 offen lds
    s_add_u32 s29, s29, 7340032
    buffer_load_dwordx4 v241, s[8:11], s41 offen offset:1024 lds
    s_and_b32 s3, s2, 31
    s_lshl_b32 s3, s3, 7
    s_add_u32 m0, s28, 0
    s_add_u32 s41, s46, 0
    buffer_load_dwordx4 v240, s[8:11], s41 offen lds
    s_add_u32 s3, s3, 11927552
    v_mov_b32 v252, s3
    buffer_load_dwordx4 v241, s[8:11], s41 offen offset:1024 lds
    v_lshlrev_b32 v216, 6, v33
    v_and_b32 v26, 3, v32
    s_add_u32 s46, s45, 13
    s_and_b32 s46, s46, 15
    s_mul_i32 s46, s46, 114688
    s_add_u32 s46, s46, s26
    s_add_u32 m0, s27, 8192
    s_add_u32 s41, s46, 4294909952
    buffer_load_dwordx4 v242, s[12:15], s41 offen lds
    v_lshl_add_u32 v216, v26, 4, v216
    v_bfe_u32 v26, v32, 2, 1
    buffer_load_dwordx4 v242, s[16:19], s41 offen offset:1024 lds
    v_mul_u32_u24 v26, 12928, v26
    v_add_u32 v216, v216, v26
    s_add_u32 m0, s64, 140544
    s_cmp_ge_u32 s67, 2
    s_cselect_b32 s47, 458752, 0
    s_add_u32 s41, s66, 425984
    s_sub_u32 s41, s41, s47
    buffer_load_dwordx4 v248, s[68:71], s41 offen lds
    v_add_u32 v216, 107136, v216
    s_lshr_b32 s6, s36, 1
    buffer_load_dwordx4 v249, s[68:71], s41 offen offset:1024 lds
    s_and_b32 s7, s36, 1
    s_mul_i32 s5, s6, 12928
    s_waitcnt vmcnt(14) lgkmcnt(0)
    s_barrier
    s_add_u32 m0, s27, 16384
    s_add_u32 s41, s46, 0
    buffer_load_dwordx4 v242, s[12:15], s41 offen lds
    s_add_u32 s5, s5, 98304
    buffer_load_dwordx4 v242, s[16:19], s41 offen offset:1024 lds
    v_and_b32 v26, 127, v0
    v_lshl_add_u32 v213, v26, 2, s5
    s_add_u32 s46, s45, 14
    s_and_b32 s46, s46, 15
    s_mul_i32 s46, s46, 114688
    s_add_u32 s46, s46, s26
    s_add_u32 m0, s27, 24576
    s_add_u32 s41, s46, 4294909952
    buffer_load_dwordx4 v242, s[12:15], s41 offen lds
    v_and_b32 v214, 60, v213
    s_mul_i32 s3, s7, 4160
    buffer_load_dwordx4 v242, s[16:19], s41 offen offset:1024 lds
    s_add_u32 s3, s3, s5
    v_add_u32 v214, s3, v214
    s_add_u32 m0, s27, 32768
    s_add_u32 s41, s46, 0
    buffer_load_dwordx4 v242, s[12:15], s41 offen lds
    v_lshlrev_b32 v215, 4, v32
    v_add_u32 v215, 98304, v215
    buffer_load_dwordx4 v242, s[16:19], s41 offen offset:1024 lds
    v_lshlrev_b32 v29, 3, v32
    v_sub_u32 v29, 2047, v29
    s_add_u32 m0, s64, 142592
    s_cmp_ge_u32 s67, 1
    s_cselect_b32 s47, 458752, 0
    s_add_u32 s41, s66, 434176
    s_sub_u32 s41, s41, s47
    buffer_load_dwordx4 v248, s[68:71], s41 offen lds
    v_cvt_f32_i32 v30, v29
    v_add_u32 v29, 17024, v29
    buffer_load_dwordx4 v249, s[68:71], s41 offen offset:1024 lds
    v_mov_b32 v31, 17152
    s_mov_b32 s3, 90400
    s_cmp_eq_u32 s24, 4
    s_cbranch_scc0 L_pi_ok
L_pi:
    v_cmp_gt_u32 vcc, 128, v250
    s_cbranch_vccz L_pi_ok
    s_sub_u32 s42, s42, 1
    s_cmp_lt_i32 s42, 0
    s_cbranch_scc1 L_pi_ok
    s_sleep 8
    global_load_dword v250, v251, s[62:63] sc1
    s_waitcnt vmcnt(0)
    s_branch L_pi
L_pi_ok:
    s_waitcnt vmcnt(12) lgkmcnt(0)
    s_barrier
    s_add_u32 s46, s44, 896
    s_and_b32 s46, s46, 1023
    s_add_u32 s46, s46, s25
    s_add_u32 m0, s28, 8192
    s_add_u32 s41, s46, 4294901760
    buffer_load_dwordx4 v240, s[8:11], s41 offen lds
    v_subrev_f32 v192, 0x00000000, v30
    v_cvt_pk_bf16_f32 v192, v192, 0
    buffer_load_dwordx4 v241, s[8:11], s41 offen offset:1024 lds
    v_subrev_u32 v24, 0, v29
    v_med3_i32 v192, v192, v24, v31
    v_lshl_add_u32 v192, v192, 2, s3
    s_add_u32 m0, s28, 16384
    s_add_u32 s41, s46, 0
    buffer_load_dwordx4 v240, s[8:11], s41 offen lds
    v_subrev_f32 v193, 0x3f800000, v30
    v_cvt_pk_bf16_f32 v193, v193, 0
    buffer_load_dwordx4 v241, s[8:11], s41 offen offset:1024 lds
    v_subrev_u32 v24, 1, v29
    v_med3_i32 v193, v193, v24, v31
    v_lshl_add_u32 v193, v193, 2, s3
    s_add_u32 s46, s45, 15
    s_and_b32 s46, s46, 15
    s_mul_i32 s46, s46, 114688
    s_add_u32 s46, s46, s26
    s_add_u32 m0, s27, 40960
    s_add_u32 s41, s46, 4294909952
    buffer_load_dwordx4 v242, s[12:15], s41 offen lds
    v_subrev_f32 v194, 0x40000000, v30
    v_cvt_pk_bf16_f32 v194, v194, 0
    buffer_load_dwordx4 v242, s[16:19], s41 offen offset:1024 lds
    v_subrev_u32 v24, 2, v29
    v_med3_i32 v194, v194, v24, v31
    v_lshl_add_u32 v194, v194, 2, s3
    s_waitcnt vmcnt(12) lgkmcnt(0)
    s_barrier
    s_add_u32 m0, s27, 49152
    s_add_u32 s41, s46, 0
    buffer_load_dwordx4 v242, s[12:15], s41 offen lds
    v_subrev_f32 v195, 0x40400000, v30
    v_cvt_pk_bf16_f32 v195, v195, 0
    buffer_load_dwordx4 v242, s[16:19], s41 offen offset:1024 lds
    v_subrev_u32 v24, 3, v29
    v_med3_i32 v195, v195, v24, v31
    v_lshl_add_u32 v195, v195, 2, s3
    s_add_u32 m0, s64, 0
    s_add_u32 s41, s66, 0
    buffer_load_dwordx4 v248, s[68:71], s41 offen lds
    v_subrev_f32 v196, 0x40800000, v30
    v_cvt_pk_bf16_f32 v196, v196, 0
    buffer_load_dwordx4 v249, s[68:71], s41 offen offset:1024 lds
    v_subrev_u32 v24, 4, v29
    v_med3_i32 v196, v196, v24, v31
    v_lshl_add_u32 v196, v196, 2, s3
    s_add_u32 m0, s64, 2048
    s_add_u32 s41, s66, 8192
    buffer_load_dwordx4 v248, s[68:71], s41 offen lds
    v_subrev_f32 v197, 0x40a00000, v30
    v_cvt_pk_bf16_f32 v197, v197, 0
    buffer_load_dwordx4 v249, s[68:71], s41 offen offset:1024 lds
    v_subrev_u32 v24, 5, v29
    v_med3_i32 v197, v197, v24, v31
    v_lshl_add_u32 v197, v197, 2, s3
    s_waitcnt vmcnt(8) lgkmcnt(0)
    s_barrier
    s_add_u32 m0, s64, 65536
    s_cmp_ge_u32 s67, 20
    s_cselect_b32 s47, 458752, 0
    s_add_u32 s41, s66, 131072
    s_sub_u32 s41, s41, s47
    buffer_load_dwordx4 v248, s[68:71], s41 offen lds
    v_subrev_f32 v198, 0x40c00000, v30
    v_cvt_pk_bf16_f32 v198, v198, 0
    buffer_load_dwordx4 v249, s[68:71], s41 offen offset:1024 lds
    v_subrev_u32 v24, 6, v29
    v_med3_i32 v198, v198, v24, v31
    v_lshl_add_u32 v198, v198, 2, s3
    s_add_u32 m0, s64, 67584
    s_cmp_ge_u32 s67, 19
    s_cselect_b32 s47, 458752, 0
    s_add_u32 s41, s66, 139264
    s_sub_u32 s41, s41, s47
    buffer_load_dwordx4 v248, s[68:71], s41 offen lds
    v_subrev_f32 v199, 0x40e00000, v30
    v_cvt_pk_bf16_f32 v199, v199, 0
    buffer_load_dwordx4 v249, s[68:71], s41 offen offset:1024 lds
    v_subrev_u32 v24, 7, v29
    v_med3_i32 v199, v199, v24, v31
    v_lshl_add_u32 v199, v199, 2, s3
    s_add_u32 m0, s64, 16384
    s_add_u32 s41, s66, 32768
    buffer_load_dwordx4 v248, s[68:71], s41 offen lds
    v_subrev_f32 v200, 0x41000000, v30
    v_cvt_pk_bf16_f32 v200, v200, 0
    buffer_load_dwordx4 v249, s[68:71], s41 offen offset:1024 lds
    v_subrev_u32 v24, 8, v29
    v_med3_i32 v200, v200, v24, v31
    v_lshl_add_u32 v200, v200, 2, s3
    s_waitcnt vmcnt(10) lgkmcnt(0)
    s_barrier
    s_add_u32 m0, s64, 18432
    s_add_u32 s41, s66, 40960
    buffer_load_dwordx4 v248, s[68:71], s41 offen lds
    buffer_load_dwordx4 v249, s[68:71], s41 offen offset:1024 lds
    s_add_u32 m0, s64, 32768
    s_cmp_ge_u32 s67, 24
    s_cselect_b32 s47, 458752, 0
    s_add_u32 s41, s66, 65536
    s_sub_u32 s41, s41, s47
    buffer_load_dwordx4 v248, s[68:71], s41 offen lds
    buffer_load_dwordx4 v249, s[68:71], s41 offen offset:1024 lds
    s_add_u32 m0, s64, 34816
    s_cmp_ge_u32 s67, 23
    s_cselect_b32 s47, 458752, 0
    s_add_u32 s41, s66, 73728
    s_sub_u32 s41, s41, s47
    buffer_load_dwordx4 v248, s[68:71], s41 offen lds
    buffer_load_dwordx4 v249, s[68:71], s41 offen offset:1024 lds
    buffer_load_dword v250, v252, s[20:23], 0 offen sc1
    s_waitcnt lgkmcnt(0)
    s_barrier
    s_add_u32 m0, s64, 81920
    s_cmp_ge_u32 s67, 18
    s_cselect_b32 s47, 458752, 0
    s_add_u32 s41, s66, 163840
    s_sub_u32 s41, s41, s47
    buffer_load_dwordx4 v248, s[68:71], s41 offen lds
    buffer_load_dwordx4 v249, s[68:71], s41 offen offset:1024 lds
    s_add_u32 m0, s64, 83968
    s_cmp_ge_u32 s67, 17
    s_cselect_b32 s47, 458752, 0
    s_add_u32 s41, s66, 172032
    s_sub_u32 s41, s41, s47
    buffer_load_dwordx4 v248, s[68:71], s41 offen lds
    buffer_load_dwordx4 v249, s[68:71], s41 offen offset:1024 lds
    s_add_u32 m0, s64, 49152
    s_cmp_ge_u32 s67, 22
    s_cselect_b32 s47, 458752, 0
    s_add_u32 s41, s66, 98304
    s_sub_u32 s41, s41, s47
    buffer_load_dwordx4 v248, s[68:71], s41 offen lds
    buffer_load_dwordx4 v249, s[68:71], s41 offen offset:1024 lds
    s_add_u32 m0, s64, 51200
    s_cmp_ge_u32 s67, 21
    s_cselect_b32 s47, 458752, 0
    s_add_u32 s41, s66, 106496
    s_sub_u32 s41, s41, s47
    buffer_load_dwordx4 v248, s[68:71], s41 offen lds
    buffer_load_dwordx4 v249, s[68:71], s41 offen offset:1024 lds
    s_setprio 0
    v_mfma_f32_16x16x32_bf16 v[176:179], v[52:55], v[48:51], 0
    v_mfma_f32_16x16x32_bf16 v[180:183], v[56:59], v[48:51], 0
    v_mfma_f32_16x16x32_bf16 v[176:179], v[64:67], v[60:63], v[176:179]
    v_mfma_f32_16x16x32_bf16 v[180:183], v[68:71], v[60:63], v[180:183]
    v_mfma_f32_16x16x32_bf16 v[176:179], v[76:79], v[72:75], v[176:179]
    v_mfma_f32_16x16x32_bf16 v[180:183], v[80:83], v[72:75], v[180:183]
    v_mfma_f32_16x16x32_bf16 v[176:179], v[88:91], v[84:87], v[176:179]
    v_mfma_f32_16x16x32_bf16 v[180:183], v[92:95], v[84:87], v[180:183]
    v_mfma_f32_16x16x32_bf16 v[176:179], v[100:103], v[96:99], v[176:179]
    v_mfma_f32_16x16x32_bf16 v[180:183], v[104:107], v[96:99], v[180:183]
    v_mfma_f32_16x16x32_bf16 v[176:179], v[112:115], v[108:111], v[176:179]
    v_mfma_f32_16x16x32_bf16 v[180:183], v[116:119], v[108:111], v[180:183]
    v_mfma_f32_16x16x32_bf16 v[176:179], v[124:127], v[120:123], v[176:179]
    v_mfma_f32_16x16x32_bf16 v[180:183], v[128:131], v[120:123], v[180:183]
    v_mfma_f32_16x16x32_bf16 v[176:179], v[136:139], v[132:135], v[176:179]
    v_mfma_f32_16x16x32_bf16 v[180:183], v[140:143], v[132:135], v[180:183]
    s_waitcnt vmcnt(8)
L_pm1:
    v_cmp_gt_u32 vcc, 1, v250
    s_cbranch_vccz L_pm1_ok
    s_sub_u32 s42, s42, 1
    s_cmp_lt_i32 s42, 0
    s_cbranch_scc1 L_pm1_ok
    s_sleep 8
    buffer_load_dword v250, v252, s[20:23], 0 offen sc1
    s_waitcnt vmcnt(0)
    s_branch L_pm1
L_pm1_ok:
    buffer_load_dwordx4 v[224:227], v217, s[20:23], s29 offen sc1
    buffer_load_dwordx4 v[228:231], v218, s[20:23], s29 offen sc1
    s_nop 7
    v_add_f32 v176, v176, v232
    v_cvt_pk_bf16_f32 v184, v176, v177
    v_cvt_pk_bf16_f32 v185, v178, v179
    v_cvt_pk_bf16_f32 v186, v180, v181
    v_cvt_pk_bf16_f32 v187, v182, v183
    ds_write_b16 v221, v184
    ds_write_b16_d16_hi v221, v184 offset:4
    ds_write_b16 v222, v185
    ds_write_b16_d16_hi v222, v185 offset:4
    ds_write_b16 v223, v186 offset:2048
    ds_write_b16_d16_hi v223, v186 offset:2112
    ds_write_b16 v223, v187 offset:2176
    ds_write_b16_d16_hi v223, v187 offset:2240
    s_mov_b64 exec, 1
    s_waitcnt lgkmcnt(0)
    ds_add_u32 v233, v253
    s_mov_b64 exec, -1
    ds_read_b64_tr_b16 v[48:49], v8 offset:0
    ds_read_b64_tr_b16 v[50:51], v8 offset:1024
    ds_read_b64_tr_b16 v[52:53], v9 offset:0
    ds_read_b64_tr_b16 v[54:55], v9 offset:1024
    ds_read_b64_tr_b16 v[56:57], v8 offset:2048
    ds_read_b64_tr_b16 v[58:59], v8 offset:3072
    ds_read_b64_tr_b16 v[60:61], v9 offset:2048
    ds_read_b64_tr_b16 v[62:63], v9 offset:3072
    s_waitcnt lgkmcnt(0)
    ds_read_b64_tr_b16 v[64:65], v10 offset:0
    ds_read_b64_tr_b16 v[66:67], v10 offset:1024
    ds_read_b64_tr_b16 v[68:69], v11 offset:0
    ds_read_b64_tr_b16 v[70:71], v11 offset:1024
    ds_read_b64_tr_b16 v[72:73], v10 offset:2048
    ds_read_b64_tr_b16 v[74:75], v10 offset:3072
    ds_read_b64_tr_b16 v[76:77], v11 offset:2048
    ds_read_b64_tr_b16 v[78:79], v11 offset:3072
    s_waitcnt lgkmcnt(0)
    s_mov_b64 exec, 1
L_pm1_k:
    ds_read_b32 v2, v233
    s_waitcnt lgkmcnt(0)
    v_cmp_gt_u32 vcc, 4, v2
    s_cbranch_vccz L_pm1_kgo
    s_sub_u32 s42, s42, 1
    s_cmp_lt_i32 s42, 0
    s_cbranch_scc0 L_pm1_k
L_pm1_kgo:
    s_mov_b64 exec, -1
    ds_read_b32 v204, v192
    ds_read_b32 v205, v193
    ds_read_b32 v206, v194
    ds_read_b32 v207, v195
    ds_read_b32 v208, v196
    ds_read_b32 v209, v197
    ds_read_b32 v210, v198
    ds_read_b32 v211, v199
    ds_read_b32 v212, v200
    ds_read_b64_tr_b16 v[80:81], v8 offset:16384
    ds_read_b64_tr_b16 v[82:83], v8 offset:17408
    ds_read_b64_tr_b16 v[84:85], v9 offset:16384
    ds_read_b64_tr_b16 v[86:87], v9 offset:17408
    ds_read_b64_tr_b16 v[88:89], v8 offset:18432
    ds_read_b64_tr_b16 v[90:91], v8 offset:19456
    ds_read_b64_tr_b16 v[92:93], v9 offset:18432
    ds_read_b64_tr_b16 v[94:95], v9 offset:19456
    ds_read_b64_tr_b16 v[96:97], v8 offset:32768
    ds_read_b64_tr_b16 v[98:99], v8 offset:33792
    ds_read_b64_tr_b16 v[100:101], v9 offset:32768
    ds_read_b64_tr_b16 v[102:103], v9 offset:33792
    ds_read_b64_tr_b16 v[104:105], v8 offset:34816
    ds_read_b64_tr_b16 v[106:107], v8 offset:35840
    ds_read_b64_tr_b16 v[108:109], v9 offset:34816
    ds_read_b64_tr_b16 v[110:111], v9 offset:35840
    s_waitcnt lgkmcnt(0)
    ds_read_b64_tr_b16 v[144:145], v12 offset:0
    ds_read_b64_tr_b16 v[146:147], v12 offset:1024
    ds_read_b64_tr_b16 v[148:149], v13 offset:0
    ds_read_b64_tr_b16 v[150:151], v13 offset:1024
    ds_read_b64_tr_b16 v[152:153], v12 offset:2048
    ds_read_b64_tr_b16 v[154:155], v12 offset:3072
    ds_read_b64_tr_b16 v[156:157], v13 offset:2048
    ds_read_b64_tr_b16 v[158:159], v13 offset:3072
    ds_read_b64_tr_b16 v[160:161], v12 offset:16384
    ds_read_b64_tr_b16 v[162:163], v12 offset:17408
    ds_read_b64_tr_b16 v[164:165], v13 offset:16384
    ds_read_b64_tr_b16 v[166:167], v13 offset:17408
    ds_read_b64_tr_b16 v[168:169], v12 offset:18432
    ds_read_b64_tr_b16 v[170:171], v12 offset:19456
    ds_read_b64_tr_b16 v[172:173], v13 offset:18432
    ds_read_b64_tr_b16 v[174:175], v13 offset:19456
    v_cmp_ne_u32 vcc, 0x1ff, v0
    ds_write_b32 v213, v251 offset:8320
    ds_write_b32 v214, v251 offset:4096
    v_cndmask_b32 v212, 0, v212, vcc
    s_mov_b32 s54, 0x05040100
    s_mov_b32 s55, 0x07060302
    v_perm_b32 v16, v205, v204, s54
    v_perm_b32 v17, v207, v206, s54
    v_perm_b32 v18, v209, v208, s54
    v_perm_b32 v19, v211, v210, s54
    ds_write_b128 v215, v[16:19] offset:0
    v_perm_b32 v20, v206, v205, s54
    v_perm_b32 v21, v208, v207, s54
    v_perm_b32 v22, v210, v209, s54
    v_perm_b32 v23, v212, v211, s54
    ds_write_b128 v215, v[20:23] offset:4160
    v_perm_b32 v24, v205, v204, s55
    v_perm_b32 v25, v207, v206, s55
    v_perm_b32 v26, v209, v208, s55
    v_perm_b32 v27, v211, v210, s55
    ds_write_b128 v215, v[24:27] offset:12928
    v_perm_b32 v28, v206, v205, s55
    v_perm_b32 v29, v208, v207, s55
    v_perm_b32 v30, v210, v209, s55
    v_perm_b32 v31, v212, v211, s55
    ds_write_b128 v215, v[28:31] offset:17088
    s_waitcnt vmcnt(2)
    ds_read_b64_tr_b16 v[112:113], v10 offset:16384
    ds_read_b64_tr_b16 v[114:115], v10 offset:17408
    ds_read_b64_tr_b16 v[116:117], v11 offset:16384
    ds_read_b64_tr_b16 v[118:119], v11 offset:17408
    ds_read_b64_tr_b16 v[120:121], v10 offset:18432
    ds_read_b64_tr_b16 v[122:123], v10 offset:19456
    ds_read_b64_tr_b16 v[124:125], v11 offset:18432
    ds_read_b64_tr_b16 v[126:127], v11 offset:19456
    ds_read_b64_tr_b16 v[128:129], v8 offset:49152
    ds_read_b64_tr_b16 v[130:131], v8 offset:50176
    ds_read_b64_tr_b16 v[132:133], v9 offset:49152
    ds_read_b64_tr_b16 v[134:135], v9 offset:50176
    ds_read_b64_tr_b16 v[136:137], v8 offset:51200
    ds_read_b64_tr_b16 v[138:139], v8 offset:52224
    ds_read_b64_tr_b16 v[140:141], v9 offset:51200
    ds_read_b64_tr_b16 v[142:143], v9 offset:52224
    s_waitcnt lgkmcnt(0)
    s_waitcnt vmcnt(0)
    ds_write_b128 v216, v[224:227]
    ds_write_b128 v216, v[228:231] offset:2048
L_b_join:
    s_cmp_eq_u32 s24, 4
    s_cbranch_scc1 L_pad_cv0
    s_cmp_eq_u32 s24, 5
    s_cbranch_scc1 L_pad_cv1
    s_cmp_eq_u32 s24, 6
    s_cbranch_scc1 L_pad_g21
    s_cmp_eq_u32 s24, 7
    s_cbranch_scc1 L_pad_g22
L_warm_ret2:
    s_waitcnt lgkmcnt(0)
    s_barrier
    s_setprio 1
    v_mov_b32 v12, v248
    v_mov_b32 v13, v249
    s_add_u32 m0, s64, 0
    s_cmp_ge_u32 s67, 16
    s_cselect_b32 s3, 458752, 0
    s_add_u32 s41, s66, 196608
    s_sub_u32 s41, s41, s3
    buffer_load_dwordx4 v12, s[68:71], s41 offen lds
    buffer_load_dwordx4 v13, s[68:71], s41 offen offset:1024 lds
    s_add_u32 m0, s64, 2048
    s_cmp_ge_u32 s67, 15
    s_cselect_b32 s3, 458752, 0
    s_add_u32 s41, s66, 204800
    s_sub_u32 s41, s41, s3
    buffer_load_dwordx4 v12, s[68:71], s41 offen lds
    buffer_load_dwordx4 v13, s[68:71], s41 offen offset:1024 lds
    s_add_u32 m0, s64, 16384
    s_cmp_ge_u32 s67, 14
    s_cselect_b32 s3, 458752, 0
    s_add_u32 s41, s66, 229376
    s_sub_u32 s41, s41, s3
    buffer_load_dwordx4 v12, s[68:71], s41 offen lds
    buffer_load_dwordx4 v13, s[68:71], s41 offen offset:1024 lds
    s_add_u32 m0, s64, 18432
    s_cmp_ge_u32 s67, 13
    s_cselect_b32 s3, 458752, 0
    s_add_u32 s41, s66, 237568
    s_sub_u32 s41, s41, s3
    buffer_load_dwordx4 v12, s[68:71], s41 offen lds
    buffer_load_dwordx4 v13, s[68:71], s41 offen offset:1024 lds
    s_add_u32 m0, s64, 32768
    s_cmp_ge_u32 s67, 12
    s_cselect_b32 s3, 458752, 0
    s_add_u32 s41, s66, 262144
    s_sub_u32 s41, s41, s3
    buffer_load_dwordx4 v12, s[68:71], s41 offen lds
    buffer_load_dwordx4 v13, s[68:71], s41 offen offset:1024 lds
    s_add_u32 m0, s64, 34816
    s_cmp_ge_u32 s67, 11
    s_cselect_b32 s3, 458752, 0
    s_add_u32 s41, s66, 270336
    s_sub_u32 s41, s41, s3
    buffer_load_dwordx4 v12, s[68:71], s41 offen lds
    buffer_load_dwordx4 v13, s[68:71], s41 offen offset:1024 lds
    s_add_u32 m0, s64, 49152
    s_cmp_ge_u32 s67, 10
    s_cselect_b32 s3, 458752, 0
    s_add_u32 s41, s66, 294912
    s_sub_u32 s41, s41, s3
    buffer_load_dwordx4 v12, s[68:71], s41 offen lds
    buffer_load_dwordx4 v13, s[68:71], s41 offen offset:1024 lds
    s_add_u32 m0, s64, 51200
    s_cmp_ge_u32 s67, 9
    s_cselect_b32 s3, 458752, 0
    s_add_u32 s41, s66, 303104
    s_sub_u32 s41, s41, s3
    buffer_load_dwordx4 v12, s[68:71], s41 offen lds
    buffer_load_dwordx4 v13, s[68:71], s41 offen offset:1024 lds
    s_mov_b64 exec, 0x3fff
    buffer_load_dword v2, v5, s[20:23], s65 offen sc1
    s_mov_b64 exec, -1
    s_add_u32 m0, s64, 65536
    s_cmp_ge_u32 s67, 8
    s_cselect_b32 s3, 458752, 0
    s_add_u32 s41, s66, 327680
    s_sub_u32 s41, s41, s3
    buffer_load_dwordx4 v12, s[68:71], s41 offen lds
    buffer_load_dwordx4 v13, s[68:71], s41 offen offset:1024 lds
    s_add_u32 m0, s64, 67584
    s_cmp_ge_u32 s67, 7
    s_cselect_b32 s3, 458752, 0
    s_add_u32 s41, s66, 335872
    s_sub_u32 s41, s41, s3
    buffer_load_dwordx4 v12, s[68:71], s41 offen lds
    buffer_load_dwordx4 v13, s[68:71], s41 offen offset:1024 lds
    s_add_u32 m0, s64, 81920
    s_cmp_ge_u32 s67, 6
    s_cselect_b32 s3, 458752, 0
    s_add_u32 s41, s66, 360448
    s_sub_u32 s41, s41, s3
    buffer_load_dwordx4 v12, s[68:71], s41 offen lds
    buffer_load_dwordx4 v13, s[68:71], s41 offen offset:1024 lds
    s_add_u32 m0, s64, 83968
    s_cmp_ge_u32 s67, 5
    s_cselect_b32 s3, 458752, 0
    s_add_u32 s41, s66, 368640
    s_sub_u32 s41, s41, s3
    buffer_load_dwordx4 v12, s[68:71], s41 offen lds
    buffer_load_dwordx4 v13, s[68:71], s41 offen offset:1024 lds
    s_movk_i32 s46, 4096
    s_mov_b64 exec, 0x3fff
    s_waitcnt vmcnt(8)
L_g2_hpoll:
    v_cmp_eq_u32 vcc, 0, v2
    s_cbranch_vccz L_g2_hready
    s_mov_b64 exec, vcc
    s_sub_u32 s42, s42, 1
    s_cmp_lt_i32 s42, 0
    s_cbranch_scc1 L_g2_hready
    buffer_load_dword v2, v5, s[20:23], s65 offen sc1
    s_waitcnt vmcnt(0)
    s_branch L_g2_hpoll
L_g2_hready:
    s_mov_b64 exec, -1
    buffer_load_dwordx4 v[16:19], v6, s[20:23], s52 offen offset:0 sc1
    buffer_load_dwordx4 v[20:23], v6, s[20:23], s53 offen offset:0 sc1
    buffer_load_dwordx4 v[24:27], v6, s[20:23], s52 offen offset:1024 sc1
    buffer_load_dwordx4 v[28:31], v6, s[20:23], s53 offen offset:1024 sc1
    buffer_load_dwordx4 v[32:35], v6, s[20:23], s52 offen offset:2048 sc1
    buffer_load_dwordx4 v[36:39], v6, s[20:23], s53 offen offset:2048 sc1
    buffer_load_dwordx4 v[40:43], v6, s[20:23], s52 offen offset:3072 sc1
    s_cmp_eq_u32 s67, 24
    s_cselect_b32 s47, 4294942720, s46
    s_add_u32 s52, s52, s47
    buffer_load_dwordx4 v[44:47], v6, s[20:23], s53 offen offset:3072 sc1
    s_add_u32 s53, s53, s47
    buffer_load_dwordx4 v[176:179], v6, s[20:23], s52 offen offset:0 sc1
    buffer_load_dwordx4 v[180:183], v6, s[20:23], s53 offen offset:0 sc1
    v_and_b32 v5, 15, v1
    v_lshlrev_b32 v5, 9, v5
    s_lshl_b32 s65, s51, 13
    s_lshr_b32 s4, s50, 3
    s_and_b32 s4, s4, 3
    s_lshl_b32 s4, s4, 7
    s_add_u32 s65, s65, s4
    s_add_u32 s65, s65, 11796480
    v_and_b32 v7, 31, v1
    v_lshlrev_b32 v14, 2, v7
    s_lshl_b32 s4, s50, 7
    s_add_u32 s5, s4, 11534336
    v_lshrrev_b32 v15, 5, v1
    v_lshl_add_u32 v3, v15, 15, v14
    s_lshl_b32 s6, s51, 17
    s_add_u32 s6, s6, s4
    s_add_u32 s6, s6, 9437184
    v_and_b32 v7, 15, v1
    v_lshlrev_b32 v7, 10, v7
    v_lshl_add_u32 v7, v15, 4, v7
    v_and_b32 v15, 16, v1
    v_lshl_add_u32 v7, v15, 1, v7
    s_lshl_b32 s7, s50, 15
    s_lshl_b32 s4, s51, 6
    s_add_u32 s7, s7, s4
    s_mov_b32 s12, s60
    s_mov_b32 s13, s61
    s_mov_b32 s14, 0x200000
    v_add_u32 v15, s64, v6
    s_waitcnt vmcnt(8)
    v_mfma_f32_32x32x16_bf16 v[192:207], v[48:51], v[16:19], 0
    buffer_load_dwordx4 v[184:187], v6, s[20:23], s52 offen offset:1024 sc1
    v_mfma_f32_32x32x16_bf16 v[208:223], v[48:51], v[20:23], 0
    v_mfma_f32_32x32x16_bf16 v[224:239], v[52:55], v[16:19], 0
    buffer_load_dwordx4 v[188:191], v6, s[20:23], s53 offen offset:1024 sc1
    v_mfma_f32_32x32x16_bf16 v[240:255], v[52:55], v[20:23], 0
    buffer_load_dwordx4 v[16:19], v6, s[20:23], s52 offen offset:2048 sc1
    buffer_load_dwordx4 v[20:23], v6, s[20:23], s53 offen offset:2048 sc1
    s_waitcnt vmcnt(10)
    v_mfma_f32_32x32x16_bf16 v[192:207], v[56:59], v[24:27], v[192:207]
    buffer_load_dwordx4 v[48:51], v6, s[20:23], s52 offen offset:3072 sc1
    s_cmp_eq_u32 s67, 20
    s_cselect_b32 s47, 4294942720, s46
    s_add_u32 s52, s52, s47
    v_mfma_f32_32x32x16_bf16 v[208:223], v[56:59], v[28:31], v[208:223]
    v_mfma_f32_32x32x16_bf16 v[224:239], v[60:63], v[24:27], v[224:239]
    buffer_load_dwordx4 v[52:55], v6, s[20:23], s53 offen offset:3072 sc1
    s_add_u32 s53, s53, s47
    v_mfma_f32_32x32x16_bf16 v[240:255], v[60:63], v[28:31], v[240:255]
    buffer_load_dwordx4 v[24:27], v6, s[20:23], s52 offen offset:0 sc1
    buffer_load_dwordx4 v[28:31], v6, s[20:23], s53 offen offset:0 sc1
    s_waitcnt vmcnt(12)
    v_mfma_f32_32x32x16_bf16 v[192:207], v[80:83], v[32:35], v[192:207]
    buffer_load_dwordx4 v[56:59], v6, s[20:23], s52 offen offset:1024 sc1
    v_mfma_f32_32x32x16_bf16 v[208:223], v[80:83], v[36:39], v[208:223]
    v_mfma_f32_32x32x16_bf16 v[224:239], v[84:87], v[32:35], v[224:239]
    buffer_load_dwordx4 v[60:63], v6, s[20:23], s53 offen offset:1024 sc1
    v_mfma_f32_32x32x16_bf16 v[240:255], v[84:87], v[36:39], v[240:255]
    buffer_load_dwordx4 v[32:35], v6, s[20:23], s52 offen offset:2048 sc1
    buffer_load_dwordx4 v[36:39], v6, s[20:23], s53 offen offset:2048 sc1
    s_waitcnt vmcnt(14)
    v_mfma_f32_32x32x16_bf16 v[192:207], v[88:91], v[40:43], v[192:207]
    buffer_load_dwordx4 v[80:83], v6, s[20:23], s52 offen offset:3072 sc1
    s_cmp_eq_u32 s67, 16
    s_cselect_b32 s47, 4294942720, s46
    s_add_u32 s52, s52, s47
    v_mfma_f32_32x32x16_bf16 v[208:223], v[88:91], v[44:47], v[208:223]
    v_mfma_f32_32x32x16_bf16 v[224:239], v[92:95], v[40:43], v[224:239]
    buffer_load_dwordx4 v[84:87], v6, s[20:23], s53 offen offset:3072 sc1
    s_add_u32 s53, s53, s47
    v_mfma_f32_32x32x16_bf16 v[240:255], v[92:95], v[44:47], v[240:255]
    s_waitcnt vmcnt(14)
    v_mfma_f32_32x32x16_bf16 v[192:207], v[96:99], v[176:179], v[192:207]
    buffer_load_dwordx4 v[40:43], v6, s[20:23], s52 offen offset:0 sc1
    v_mfma_f32_32x32x16_bf16 v[208:223], v[96:99], v[180:183], v[208:223]
    v_mfma_f32_32x32x16_bf16 v[224:239], v[100:103], v[176:179], v[224:239]
    buffer_load_dwordx4 v[44:47], v6, s[20:23], s53 offen offset:0 sc1
    v_mfma_f32_32x32x16_bf16 v[240:255], v[100:103], v[180:183], v[240:255]
    s_waitcnt vmcnt(14)
    v_mfma_f32_32x32x16_bf16 v[192:207], v[104:107], v[184:187], v[192:207]
    buffer_load_dwordx4 v[88:91], v6, s[20:23], s52 offen offset:1024 sc1
    v_mfma_f32_32x32x16_bf16 v[208:223], v[104:107], v[188:191], v[208:223]
    v_mfma_f32_32x32x16_bf16 v[224:239], v[108:111], v[184:187], v[224:239]
    buffer_load_dwordx4 v[92:95], v6, s[20:23], s53 offen offset:1024 sc1
    v_mfma_f32_32x32x16_bf16 v[240:255], v[108:111], v[188:191], v[240:255]
    s_waitcnt vmcnt(14)
    v_mfma_f32_32x32x16_bf16 v[192:207], v[128:131], v[16:19], v[192:207]
    buffer_load_dwordx4 v[176:179], v6, s[20:23], s52 offen offset:2048 sc1
    v_mfma_f32_32x32x16_bf16 v[208:223], v[128:131], v[20:23], v[208:223]
    v_mfma_f32_32x32x16_bf16 v[224:239], v[132:135], v[16:19], v[224:239]
    buffer_load_dwordx4 v[180:183], v6, s[20:23], s53 offen offset:2048 sc1
    v_mfma_f32_32x32x16_bf16 v[240:255], v[132:135], v[20:23], v[240:255]
    s_waitcnt vmcnt(14)
    v_mfma_f32_32x32x16_bf16 v[192:207], v[136:139], v[48:51], v[192:207]
    buffer_load_dwordx4 v[96:99], v6, s[20:23], s52 offen offset:3072 sc1
    s_cmp_eq_u32 s67, 12
    s_cselect_b32 s47, 4294942720, s46
    s_add_u32 s52, s52, s47
    v_mfma_f32_32x32x16_bf16 v[208:223], v[136:139], v[52:55], v[208:223]
    v_mfma_f32_32x32x16_bf16 v[224:239], v[140:143], v[48:51], v[224:239]
    buffer_load_dwordx4 v[100:103], v6, s[20:23], s53 offen offset:3072 sc1
    s_add_u32 s53, s53, s47
    v_mfma_f32_32x32x16_bf16 v[240:255], v[140:143], v[52:55], v[240:255]
    s_waitcnt vmcnt(14)
    v_mfma_f32_32x32x16_bf16 v[192:207], v[64:67], v[24:27], v[192:207]
    buffer_load_dwordx4 v[184:187], v6, s[20:23], s52 offen offset:0 sc1
    ds_read_b64_tr_b16 v[140:141], v8 offset:0
    v_mfma_f32_32x32x16_bf16 v[208:223], v[64:67], v[28:31], v[208:223]
    ds_read_b64_tr_b16 v[142:143], v8 offset:1024
    v_mfma_f32_32x32x16_bf16 v[224:239], v[68:71], v[24:27], v[224:239]
    buffer_load_dwordx4 v[188:191], v6, s[20:23], s53 offen offset:0 sc1
    ds_read_b64_tr_b16 v[136:137], v9 offset:0
    v_mfma_f32_32x32x16_bf16 v[240:255], v[68:71], v[28:31], v[240:255]
    ds_read_b64_tr_b16 v[138:139], v9 offset:1024
    s_branch L_skip_g21
L_pad_g21:
    s_branch L_warm_ret2
L_skip_g21:
    s_waitcnt vmcnt(14)
    v_mfma_f32_32x32x16_bf16 v[192:207], v[72:75], v[56:59], v[192:207]
    buffer_load_dwordx4 v[104:107], v6, s[20:23], s52 offen offset:1024 sc1
    ds_read_b64_tr_b16 v[68:69], v8 offset:2048
    v_mfma_f32_32x32x16_bf16 v[208:223], v[72:75], v[60:63], v[208:223]
    ds_read_b64_tr_b16 v[70:71], v8 offset:3072
    v_mfma_f32_32x32x16_bf16 v[224:239], v[76:79], v[56:59], v[224:239]
    buffer_load_dwordx4 v[108:111], v6, s[20:23], s53 offen offset:1024 sc1
    ds_read_b64_tr_b16 v[64:65], v9 offset:2048
    v_mfma_f32_32x32x16_bf16 v[240:255], v[76:79], v[60:63], v[240:255]
    ds_read_b64_tr_b16 v[66:67], v9 offset:3072
    s_waitcnt vmcnt(14)
    v_mfma_f32_32x32x16_bf16 v[192:207], v[112:115], v[32:35], v[192:207]
    buffer_load_dwordx4 v[16:19], v6, s[20:23], s52 offen offset:2048 sc1
    ds_read_b64_tr_b16 v[76:77], v8 offset:16384
    v_mfma_f32_32x32x16_bf16 v[208:223], v[112:115], v[36:39], v[208:223]
    ds_read_b64_tr_b16 v[78:79], v8 offset:17408
    v_mfma_f32_32x32x16_bf16 v[224:239], v[116:119], v[32:35], v[224:239]
    buffer_load_dwordx4 v[20:23], v6, s[20:23], s53 offen offset:2048 sc1
    ds_read_b64_tr_b16 v[72:73], v9 offset:16384
    v_mfma_f32_32x32x16_bf16 v[240:255], v[116:119], v[36:39], v[240:255]
    ds_read_b64_tr_b16 v[74:75], v9 offset:17408
    s_waitcnt vmcnt(14)
    v_mfma_f32_32x32x16_bf16 v[192:207], v[120:123], v[80:83], v[192:207]
    buffer_load_dwordx4 v[128:131], v6, s[20:23], s52 offen offset:3072 sc1
    s_cmp_eq_u32 s67, 8
    s_cselect_b32 s47, 4294942720, s46
    s_add_u32 s52, s52, s47
    ds_read_b64_tr_b16 v[116:117], v8 offset:18432
    v_mfma_f32_32x32x16_bf16 v[208:223], v[120:123], v[84:87], v[208:223]
    ds_read_b64_tr_b16 v[118:119], v8 offset:19456
    v_mfma_f32_32x32x16_bf16 v[224:239], v[124:127], v[80:83], v[224:239]
    buffer_load_dwordx4 v[132:135], v6, s[20:23], s53 offen offset:3072 sc1
    s_add_u32 s53, s53, s47
    ds_read_b64_tr_b16 v[112:113], v9 offset:18432
    v_mfma_f32_32x32x16_bf16 v[240:255], v[124:127], v[84:87], v[240:255]
    ds_read_b64_tr_b16 v[114:115], v9 offset:19456
    s_waitcnt vmcnt(14)
    s_waitcnt lgkmcnt(12)
    v_mfma_f32_32x32x16_bf16 v[192:207], v[140:143], v[40:43], v[192:207]
    buffer_load_dwordx4 v[48:51], v6, s[20:23], s52 offen offset:0 sc1
    ds_read_b64_tr_b16 v[124:125], v8 offset:32768
    v_mfma_f32_32x32x16_bf16 v[208:223], v[140:143], v[44:47], v[208:223]
    ds_read_b64_tr_b16 v[126:127], v8 offset:33792
    v_mfma_f32_32x32x16_bf16 v[224:239], v[136:139], v[40:43], v[224:239]
    buffer_load_dwordx4 v[52:55], v6, s[20:23], s53 offen offset:0 sc1
    ds_read_b64_tr_b16 v[120:121], v9 offset:32768
    v_mfma_f32_32x32x16_bf16 v[240:255], v[136:139], v[44:47], v[240:255]
    ds_read_b64_tr_b16 v[122:123], v9 offset:33792
    s_waitcnt vmcnt(14)
    s_waitcnt lgkmcnt(12)
    v_mfma_f32_32x32x16_bf16 v[192:207], v[68:71], v[88:91], v[192:207]
    buffer_load_dwordx4 v[24:27], v6, s[20:23], s52 offen offset:1024 sc1
    ds_read_b64_tr_b16 v[136:137], v8 offset:34816
    v_mfma_f32_32x32x16_bf16 v[208:223], v[68:71], v[92:95], v[208:223]
    ds_read_b64_tr_b16 v[138:139], v8 offset:35840
    v_mfma_f32_32x32x16_bf16 v[224:239], v[64:67], v[88:91], v[224:239]
    buffer_load_dwordx4 v[28:31], v6, s[20:23], s53 offen offset:1024 sc1
    ds_read_b64_tr_b16 v[140:141], v9 offset:34816
    v_mfma_f32_32x32x16_bf16 v[240:255], v[64:67], v[92:95], v[240:255]
    ds_read_b64_tr_b16 v[142:143], v9 offset:35840
    s_waitcnt vmcnt(14)
    s_waitcnt lgkmcnt(12)
    v_mfma_f32_32x32x16_bf16 v[192:207], v[76:79], v[176:179], v[192:207]
    buffer_load_dwordx4 v[56:59], v6, s[20:23], s52 offen offset:2048 sc1
    ds_read_b64_tr_b16 v[64:65], v8 offset:49152
    v_mfma_f32_32x32x16_bf16 v[208:223], v[76:79], v[180:183], v[208:223]
    ds_read_b64_tr_b16 v[66:67], v8 offset:50176
    v_mfma_f32_32x32x16_bf16 v[224:239], v[72:75], v[176:179], v[224:239]
    buffer_load_dwordx4 v[60:63], v6, s[20:23], s53 offen offset:2048 sc1
    ds_read_b64_tr_b16 v[68:69], v9 offset:49152
    v_mfma_f32_32x32x16_bf16 v[240:255], v[72:75], v[180:183], v[240:255]
    ds_read_b64_tr_b16 v[70:71], v9 offset:50176
    s_waitcnt vmcnt(14)
    s_waitcnt lgkmcnt(12)
    v_mfma_f32_32x32x16_bf16 v[192:207], v[116:119], v[96:99], v[192:207]
    buffer_load_dwordx4 v[32:35], v6, s[20:23], s52 offen offset:3072 sc1
    s_cmp_eq_u32 s67, 4
    s_cselect_b32 s47, 4294942720, s46
    s_add_u32 s52, s52, s47
    ds_read_b64_tr_b16 v[72:73], v8 offset:51200
    v_mfma_f32_32x32x16_bf16 v[208:223], v[116:119], v[100:103], v[208:223]
    ds_read_b64_tr_b16 v[74:75], v8 offset:52224
    v_mfma_f32_32x32x16_bf16 v[224:239], v[112:115], v[96:99], v[224:239]
    buffer_load_dwordx4 v[36:39], v6, s[20:23], s53 offen offset:3072 sc1
    s_add_u32 s53, s53, s47
    ds_read_b64_tr_b16 v[76:77], v9 offset:51200
    v_mfma_f32_32x32x16_bf16 v[240:255], v[112:115], v[100:103], v[240:255]
    ds_read_b64_tr_b16 v[78:79], v9 offset:52224
    s_waitcnt vmcnt(14)
    s_waitcnt lgkmcnt(12)
    v_mfma_f32_32x32x16_bf16 v[192:207], v[124:127], v[184:187], v[192:207]
    buffer_load_dwordx4 v[80:83], v6, s[20:23], s52 offen offset:0 sc1
    ds_read_b64_tr_b16 v[112:113], v10 offset:0
    v_mfma_f32_32x32x16_bf16 v[208:223], v[124:127], v[188:191], v[208:223]
    ds_read_b64_tr_b16 v[114:115], v10 offset:1024
    v_mfma_f32_32x32x16_bf16 v[224:239], v[120:123], v[184:187], v[224:239]
    buffer_load_dwordx4 v[84:87], v6, s[20:23], s53 offen offset:0 sc1
    ds_read_b64_tr_b16 v[116:117], v11 offset:0
    v_mfma_f32_32x32x16_bf16 v[240:255], v[120:123], v[188:191], v[240:255]
    ds_read_b64_tr_b16 v[118:119], v11 offset:1024
    s_waitcnt vmcnt(14)
    s_waitcnt lgkmcnt(12)
    v_mfma_f32_32x32x16_bf16 v[192:207], v[136:139], v[104:107], v[192:207]
    buffer_load_dwordx4 v[40:43], v6, s[20:23], s52 offen offset:1024 sc1
    ds_read_b64_tr_b16 v[120:121], v10 offset:2048
    v_mfma_f32_32x32x16_bf16 v[208:223], v[136:139], v[108:111], v[208:223]
    ds_read_b64_tr_b16 v[122:123], v10 offset:3072
    v_mfma_f32_32x32x16_bf16 v[224:239], v[140:143], v[104:107], v[224:239]
    buffer_load_dwordx4 v[44:47], v6, s[20:23], s53 offen offset:1024 sc1
    ds_read_b64_tr_b16 v[124:125], v11 offset:2048
    v_mfma_f32_32x32x16_bf16 v[240:255], v[140:143], v[108:111], v[240:255]
    ds_read_b64_tr_b16 v[126:127], v11 offset:3072
    s_waitcnt vmcnt(14)
    s_waitcnt lgkmcnt(12)
    v_mfma_f32_32x32x16_bf16 v[192:207], v[64:67], v[16:19], v[192:207]
    buffer_load_dwordx4 v[88:91], v6, s[20:23], s52 offen offset:2048 sc1
    ds_read_b64_tr_b16 v[140:141], v10 offset:16384
    v_mfma_f32_32x32x16_bf16 v[208:223], v[64:67], v[20:23], v[208:223]
    ds_read_b64_tr_b16 v[142:143], v10 offset:17408
    v_mfma_f32_32x32x16_bf16 v[224:239], v[68:71], v[16:19], v[224:239]
    buffer_load_dwordx4 v[92:95], v6, s[20:23], s53 offen offset:2048 sc1
    ds_read_b64_tr_b16 v[136:137], v11 offset:16384
    v_mfma_f32_32x32x16_bf16 v[240:255], v[68:71], v[20:23], v[240:255]
    ds_read_b64_tr_b16 v[138:139], v11 offset:17408
    s_waitcnt vmcnt(14)
    s_waitcnt lgkmcnt(12)
    v_mfma_f32_32x32x16_bf16 v[192:207], v[72:75], v[128:131], v[192:207]
    buffer_load_dwordx4 v[176:179], v6, s[20:23], s52 offen offset:3072 sc1
    ds_read_b64_tr_b16 v[68:69], v10 offset:18432
    v_mfma_f32_32x32x16_bf16 v[208:223], v[72:75], v[132:135], v[208:223]
    ds_read_b64_tr_b16 v[70:71], v10 offset:19456
    v_mfma_f32_32x32x16_bf16 v[224:239], v[76:79], v[128:131], v[224:239]
    buffer_load_dwordx4 v[180:183], v6, s[20:23], s53 offen offset:3072 sc1
    ds_read_b64_tr_b16 v[64:65], v11 offset:18432
    v_mfma_f32_32x32x16_bf16 v[240:255], v[76:79], v[132:135], v[240:255]
    ds_read_b64_tr_b16 v[66:67], v11 offset:19456
    s_waitcnt vmcnt(14)
    s_waitcnt lgkmcnt(12)
    v_mfma_f32_32x32x16_bf16 v[192:207], v[112:115], v[48:51], v[192:207]
    v_mfma_f32_32x32x16_bf16 v[208:223], v[112:115], v[52:55], v[208:223]
    v_mfma_f32_32x32x16_bf16 v[224:239], v[116:119], v[48:51], v[224:239]
    v_mfma_f32_32x32x16_bf16 v[240:255], v[116:119], v[52:55], v[240:255]
    buffer_load_dword v2, v5, s[20:23], s65 offen sc1
    s_waitcnt vmcnt(13)
    s_waitcnt lgkmcnt(8)
    v_mfma_f32_32x32x16_bf16 v[192:207], v[120:123], v[24:27], v[192:207]
    v_mfma_f32_32x32x16_bf16 v[208:223], v[120:123], v[28:31], v[208:223]
    v_mfma_f32_32x32x16_bf16 v[224:239], v[124:127], v[24:27], v[224:239]
    v_mfma_f32_32x32x16_bf16 v[240:255], v[124:127], v[28:31], v[240:255]
    s_waitcnt vmcnt(11)
    s_waitcnt lgkmcnt(4)
    v_mfma_f32_32x32x16_bf16 v[192:207], v[140:143], v[56:59], v[192:207]
    v_mfma_f32_32x32x16_bf16 v[208:223], v[140:143], v[60:63], v[208:223]
    v_mfma_f32_32x32x16_bf16 v[224:239], v[136:139], v[56:59], v[224:239]
    v_mfma_f32_32x32x16_bf16 v[240:255], v[136:139], v[60:63], v[240:255]
    s_waitcnt vmcnt(9)
    s_waitcnt lgkmcnt(0)
    v_mfma_f32_32x32x16_bf16 v[192:207], v[68:71], v[32:35], v[192:207]
    v_mfma_f32_32x32x16_bf16 v[208:223], v[68:71], v[36:39], v[208:223]
    v_mfma_f32_32x32x16_bf16 v[224:239], v[64:67], v[32:35], v[224:239]
    v_mfma_f32_32x32x16_bf16 v[240:255], v[64:67], v[36:39], v[240:255]
    s_waitcnt vmcnt(0)
L_g2_poll:
    v_cmp_eq_u32 vcc, 0, v2
    s_cbranch_vccz L_g2_ready
    s_sub_u32 s42, s42, 1
    s_cmp_lt_i32 s42, 0
    s_cbranch_scc1 L_g2_ready
    s_mov_b64 exec, vcc
    s_sleep 2
L_g2_reload:
    buffer_load_dword v2, v5, s[20:23], s65 offen sc1
    s_waitcnt vmcnt(0)
    s_branch L_g2_poll
L_pad_g22:
    s_branch L_warm_ret2
L_g2_ready:
    s_mov_b64 exec, -1
    v_xor_b32 v8, 0x1000, v15
    v_xor_b32 v9, 0x2000, v15
    v_xor_b32 v10, 0x3000, v15
    v_mfma_f32_32x32x16_bf16 v[208:223], v[144:147], v[84:87], v[208:223]
    buffer_load_dword v4, v14, s[20:23], s5 offen sc1
    v_mfma_f32_32x32x16_bf16 v[208:223], v[152:155], v[44:47], v[208:223]
    buffer_load_dword v96, v3, s[20:23], s6 offen sc1
    s_add_u32 s6, s6, 8192
    v_mfma_f32_32x32x16_bf16 v[208:223], v[160:163], v[92:95], v[208:223]
    buffer_load_dword v97, v3, s[20:23], s6 offen sc1
    s_add_u32 s6, s6, 8192
    v_mfma_f32_32x32x16_bf16 v[208:223], v[168:171], v[180:183], v[208:223]
    buffer_load_dword v98, v3, s[20:23], s6 offen sc1
    s_add_u32 s6, s6, 8192
    v_mfma_f32_32x32x16_bf16 v[224:239], v[148:151], v[80:83], v[224:239]
    buffer_load_dword v99, v3, s[20:23], s6 offen sc1
    s_add_u32 s6, s6, 40960
    s_nop 7
    v_mfma_f32_32x32x16_bf16 v[224:239], v[156:159], v[40:43], v[224:239]
    buffer_load_dword v100, v3, s[20:23], s6 offen sc1
    s_add_u32 s6, s6, 8192
    s_nop 1
    ds_write_b128 v15, v[208:211] offset:0
    ds_write_b128 v15, v[212:215] offset:1024
    v_mfma_f32_32x32x16_bf16 v[224:239], v[164:167], v[88:91], v[224:239]
    buffer_load_dword v101, v3, s[20:23], s6 offen sc1
    s_add_u32 s6, s6, 8192
    ds_write_b128 v15, v[216:219] offset:2048
    ds_write_b128 v15, v[220:223] offset:3072
    v_mfma_f32_32x32x16_bf16 v[224:239], v[172:175], v[176:179], v[224:239]
    buffer_load_dword v102, v3, s[20:23], s6 offen sc1
    s_add_u32 s6, s6, 8192
    v_mfma_f32_32x32x16_bf16 v[240:255], v[148:151], v[84:87], v[240:255]
    buffer_load_dword v103, v3, s[20:23], s6 offen sc1
    s_nop 7
    v_mfma_f32_32x32x16_bf16 v[240:255], v[156:159], v[44:47], v[240:255]
    s_nop 1
    ds_write_b128 v15, v[224:227] offset:16384
    ds_write_b128 v15, v[228:231] offset:17408
    v_mfma_f32_32x32x16_bf16 v[240:255], v[164:167], v[92:95], v[240:255]
    ds_write_b128 v15, v[232:235] offset:18432
    ds_write_b128 v15, v[236:239] offset:19456
    v_mfma_f32_32x32x16_bf16 v[240:255], v[172:175], v[180:183], v[240:255]
    v_mfma_f32_32x32x16_bf16 v[192:207], v[144:147], v[80:83], v[192:207]
    s_nop 7
    v_mfma_f32_32x32x16_bf16 v[192:207], v[152:155], v[40:43], v[192:207]
    s_nop 1
    ds_write_b128 v15, v[240:243] offset:32768
    ds_write_b128 v15, v[244:247] offset:33792
    v_mfma_f32_32x32x16_bf16 v[192:207], v[160:163], v[88:91], v[192:207]
    ds_write_b128 v15, v[248:251] offset:34816
    ds_write_b128 v15, v[252:255] offset:35840
    v_mfma_f32_32x32x16_bf16 v[192:207], v[168:171], v[176:179], v[192:207]
    s_waitcnt lgkmcnt(0)
    s_barrier
    ds_read_b128 v[32:35], v8 offset:0
    ds_read_b128 v[36:39], v8 offset:1024
    ds_read_b128 v[40:43], v8 offset:2048
    ds_read_b128 v[44:47], v8 offset:3072
    ds_read_b128 v[48:51], v9 offset:16384
    ds_read_b128 v[52:55], v9 offset:17408
    ds_read_b128 v[56:59], v9 offset:18432
    ds_read_b128 v[60:63], v9 offset:19456
    ds_read_b128 v[64:67], v10 offset:32768
    ds_read_b128 v[68:71], v10 offset:33792
    ds_read_b128 v[72:75], v10 offset:34816
    ds_read_b128 v[76:79], v10 offset:35840
    s_waitcnt vmcnt(0)
    v_lshlrev_b32 v5, 16, v4
    v_and_b32 v4, 0xffff0000, v4
    v_lshlrev_b32 v80, 16, v96
    v_and_b32 v81, 0xffff0000, v96
    v_lshlrev_b32 v82, 16, v97
    v_and_b32 v83, 0xffff0000, v97
    v_lshlrev_b32 v84, 16, v98
    v_and_b32 v85, 0xffff0000, v98
    v_lshlrev_b32 v86, 16, v99
    v_and_b32 v87, 0xffff0000, v99
    v_lshlrev_b32 v88, 16, v100
    v_and_b32 v89, 0xffff0000, v100
    v_lshlrev_b32 v90, 16, v101
    v_and_b32 v91, 0xffff0000, v101
    v_lshlrev_b32 v92, 16, v102
    v_and_b32 v93, 0xffff0000, v102
    v_lshlrev_b32 v94, 16, v103
    v_and_b32 v95, 0xffff0000, v103
    v_pk_mul_f32 v[80:81], v[80:81], v[4:5] op_sel:[0,1]
    v_pk_mul_f32 v[82:83], v[82:83], v[4:5] op_sel:[0,1]
    v_pk_mul_f32 v[84:85], v[84:85], v[4:5] op_sel:[0,1]
    v_pk_mul_f32 v[86:87], v[86:87], v[4:5] op_sel:[0,1]
    v_pk_mul_f32 v[88:89], v[88:89], v[4:5] op_sel:[0,1]
    v_pk_mul_f32 v[90:91], v[90:91], v[4:5] op_sel:[0,1]
    v_pk_mul_f32 v[92:93], v[92:93], v[4:5] op_sel:[0,1]
    v_pk_mul_f32 v[94:95], v[94:95], v[4:5] op_sel:[0,1]
    s_waitcnt lgkmcnt(8)
    v_pk_add_f32 v[192:193], v[192:193], v[32:33]
    v_pk_add_f32 v[194:195], v[194:195], v[34:35]
    v_pk_add_f32 v[196:197], v[196:197], v[36:37]
    v_pk_add_f32 v[198:199], v[198:199], v[38:39]
    v_pk_add_f32 v[200:201], v[200:201], v[40:41]
    v_pk_add_f32 v[202:203], v[202:203], v[42:43]
    v_pk_add_f32 v[204:205], v[204:205], v[44:45]
    v_pk_add_f32 v[206:207], v[206:207], v[46:47]
    s_waitcnt lgkmcnt(4)
    v_pk_add_f32 v[192:193], v[192:193], v[48:49]
    v_pk_add_f32 v[194:195], v[194:195], v[50:51]
    v_pk_add_f32 v[196:197], v[196:197], v[52:53]
    v_pk_add_f32 v[198:199], v[198:199], v[54:55]
    v_pk_add_f32 v[200:201], v[200:201], v[56:57]
    v_pk_add_f32 v[202:203], v[202:203], v[58:59]
    v_pk_add_f32 v[204:205], v[204:205], v[60:61]
    v_pk_add_f32 v[206:207], v[206:207], v[62:63]
    s_waitcnt lgkmcnt(0)
    v_pk_add_f32 v[192:193], v[192:193], v[64:65]
    v_pk_add_f32 v[194:195], v[194:195], v[66:67]
    v_pk_add_f32 v[196:197], v[196:197], v[68:69]
    v_pk_add_f32 v[198:199], v[198:199], v[70:71]
    v_pk_add_f32 v[200:201], v[200:201], v[72:73]
    v_pk_add_f32 v[202:203], v[202:203], v[74:75]
    v_pk_add_f32 v[204:205], v[204:205], v[76:77]
    v_pk_add_f32 v[206:207], v[206:207], v[78:79]
    v_pk_fma_f32 v[32:33], v[192:193], v[4:5], v[80:81] op_sel_hi:[1,0,1]
    v_pk_fma_f32 v[34:35], v[194:195], v[4:5], v[82:83] op_sel_hi:[1,0,1]
    v_pk_fma_f32 v[36:37], v[196:197], v[4:5], v[84:85] op_sel_hi:[1,0,1]
    v_pk_fma_f32 v[38:39], v[198:199], v[4:5], v[86:87] op_sel_hi:[1,0,1]
    v_pk_fma_f32 v[40:41], v[200:201], v[4:5], v[88:89] op_sel_hi:[1,0,1]
    v_pk_fma_f32 v[42:43], v[202:203], v[4:5], v[90:91] op_sel_hi:[1,0,1]
    v_pk_fma_f32 v[44:45], v[204:205], v[4:5], v[92:93] op_sel_hi:[1,0,1]
    v_pk_fma_f32 v[46:47], v[206:207], v[4:5], v[94:95] op_sel_hi:[1,0,1]
    v_cvt_pk_bf16_f32 v24, v32, v33
    v_cvt_pk_bf16_f32 v25, v34, v35
    v_cvt_pk_bf16_f32 v26, v36, v37
    v_cvt_pk_bf16_f32 v27, v38, v39
    v_cvt_pk_bf16_f32 v28, v40, v41
    v_cvt_pk_bf16_f32 v29, v42, v43
    v_cvt_pk_bf16_f32 v30, v44, v45
    v_cvt_pk_bf16_f32 v31, v46, v47
    s_add_u32 s4, s7, 16384
    s_nop 0
    v_permlane16_swap_b32 v24, v28
    v_permlane16_swap_b32 v25, v29
    v_permlane16_swap_b32 v26, v30
    v_permlane16_swap_b32 v27, v31
    buffer_store_dwordx4 v[24:27], v7, s[12:15], s7 offen sc1
    buffer_store_dwordx4 v[28:31], v7, s[12:15], s4 offen sc1
    s_endpgm
L_mv_head2:
    s_mov_b32 s100, 1
    v_and_b32 v127, 127, v0
    v_lshlrev_b32 v127, 2, v127
    s_lshr_b32 s6, s36, 1
    s_mul_i32 s4, s6, 30096
    s_add_u32 s4, s4, 98304
    v_add_u32 v127, s4, v127
    s_mov_b32 s54, 0x3fb8aa3b
    s_mov_b32 s55, 0x32a57060
    s_mov_b32 s68, s56
    s_mov_b32 s69, s57
    s_mov_b32 s70, 1835008
    s_mov_b32 s71, 0x00020000
    s_and_b32 s67, s2, 7
    s_cmp_eq_u32 s67, 7
    s_cselect_b32 s67, 3, s67
    s_and_b32 s3, s39, 1
    s_mul_i32 s3, s3, 0
    s_add_u32 s67, s67, s3
    s_mul_i32 s3, s67, 37
    s_lshr_b32 s3, s3, 8
    s_mul_i32 s3, s3, 7
    s_sub_u32 s67, s67, s3
    s_lshl_b32 s67, s67, 2
    s_mov_b32 s42, 4194304
    s_lshl_b32 s3, s2, 2
    s_load_dword s48, s[78:79], s3
    s_waitcnt vmcnt(17)
    v_lshlrev_b32 v120, 16, v120
    v_lshlrev_b32 v16, 16, v121
    v_lshlrev_b32 v17, 16, v122
    v_mul_f32 v18, s54, v120
    v_fma_f32 v19, v120, s54, -v18
    v_fma_f32 v19, v120, s55, v19
    v_exp_f32 v18, v18
    v_mul_f32 v19, 0x3f317218, v19
    v_fmac_f32 v18, v18, v19
    v_cvt_pk_bf16_f32 v18, 0, v18
    v_mul_f32 v16, v18, v16
    v_mul_f32 v17, v18, v17
    v_mul_f32 v16, s54, v16
    v_mul_f32 v17, 0.15915494, v17
    v_mul_f32 v40, 0x43000000, v16
    v_mul_f32 v41, 0x43000000, v17
    v_exp_f32 v40, v40
    v_fract_f32 v41, v41
    v_cos_f32 v20, v41
    v_sin_f32 v21, v41
    v_mul_f32 v20, v40, v20
    v_mul_f32 v21, v40, v21
    v_mul_f32 v42, 0x40000000, v16
    v_mul_f32 v43, 0x40000000, v17
    v_exp_f32 v42, v42
    v_fract_f32 v43, v43
    v_cos_f32 v24, v43
    v_sin_f32 v25, v43
    v_mul_f32 v24, v42, v24
    v_mul_f32 v25, v42, v25
    v_mov_b32 v111, 0x3f80
    ds_write_b32 v127, v111 offset:8448
    v_pk_mul_f32 v[44:45], v[20:21], v[20:21] op_sel_hi:[0,1]
    v_pk_fma_f32 v[44:45], v[20:21], v[20:21], v[44:45] op_sel:[1,1,0] op_sel_hi:[1,0,1] neg_lo:[0,1,0]
    v_pk_mul_f32 v[28:29], v[24:25], v[24:25] op_sel_hi:[0,1]
    v_pk_fma_f32 v[28:29], v[24:25], v[24:25], v[28:29] op_sel:[1,1,0] op_sel_hi:[1,0,1] neg_lo:[0,1,0]
    v_pk_mul_f32 v[38:39], v[44:45], v[20:21] op_sel_hi:[0,1]
    v_pk_fma_f32 v[38:39], v[44:45], v[20:21], v[38:39] op_sel:[1,1,0] op_sel_hi:[1,0,1] neg_lo:[0,1,0]
    v_pk_mul_f32 v[32:33], v[28:29], v[24:25] op_sel_hi:[0,1]
    v_pk_fma_f32 v[32:33], v[28:29], v[24:25], v[32:33] op_sel:[1,1,0] op_sel_hi:[1,0,1] neg_lo:[0,1,0]
    v_pk_mul_f32 v[96:97], v[44:45], v[44:45] op_sel_hi:[0,1]
    v_pk_fma_f32 v[96:97], v[44:45], v[44:45], v[96:97] op_sel:[1,1,0] op_sel_hi:[1,0,1] neg_lo:[0,1,0]
    v_cvt_pk_bf16_f32 v108, v44, v45
    ds_write_b32 v127, v108 offset:16896
    v_pk_mul_f32 v[40:41], v[44:45], v[24:25] op_sel_hi:[0,1]
    v_pk_fma_f32 v[40:41], v[44:45], v[24:25], v[40:41] op_sel:[1,1,0] op_sel_hi:[1,0,1] neg_lo:[0,1,0]
    v_cvt_pk_bf16_f32 v109, v40, v41
    ds_write_b32 v127, v109 offset:17424
    v_pk_mul_f32 v[42:43], v[44:45], v[28:29] op_sel_hi:[0,1]
    v_pk_fma_f32 v[42:43], v[44:45], v[28:29], v[42:43] op_sel:[1,1,0] op_sel_hi:[1,0,1] neg_lo:[0,1,0]
    v_cvt_pk_bf16_f32 v110, v42, v43
    ds_write_b32 v127, v110 offset:17952
    v_pk_mul_f32 v[40:41], v[44:45], v[32:33] op_sel_hi:[0,1]
    v_pk_fma_f32 v[40:41], v[44:45], v[32:33], v[40:41] op_sel:[1,1,0] op_sel_hi:[1,0,1] neg_lo:[0,1,0]
    v_cvt_pk_bf16_f32 v111, v40, v41
    ds_write_b32 v127, v111 offset:18480
    v_pk_mul_f32 v[100:101], v[38:39], v[44:45] op_sel_hi:[0,1]
    v_pk_fma_f32 v[100:101], v[38:39], v[44:45], v[100:101] op_sel:[1,1,0] op_sel_hi:[1,0,1] neg_lo:[0,1,0]
    v_cvt_pk_bf16_f32 v108, v38, v39
    ds_write_b32 v127, v108 offset:19008
    v_pk_mul_f32 v[42:43], v[38:39], v[24:25] op_sel_hi:[0,1]
    v_pk_fma_f32 v[42:43], v[38:39], v[24:25], v[42:43] op_sel:[1,1,0] op_sel_hi:[1,0,1] neg_lo:[0,1,0]
    v_cvt_pk_bf16_f32 v109, v42, v43
    ds_write_b32 v127, v109 offset:19536
    v_pk_mul_f32 v[40:41], v[38:39], v[28:29] op_sel_hi:[0,1]
    v_pk_fma_f32 v[40:41], v[38:39], v[28:29], v[40:41] op_sel:[1,1,0] op_sel_hi:[1,0,1] neg_lo:[0,1,0]
    v_cvt_pk_bf16_f32 v110, v40, v41
    ds_write_b32 v127, v110 offset:20064
    v_pk_mul_f32 v[42:43], v[38:39], v[32:33] op_sel_hi:[0,1]
    v_pk_fma_f32 v[42:43], v[38:39], v[32:33], v[42:43] op_sel:[1,1,0] op_sel_hi:[1,0,1] neg_lo:[0,1,0]
    v_cvt_pk_bf16_f32 v111, v42, v43
    ds_write_b32 v127, v111 offset:20592
    v_pk_mul_f32 v[98:99], v[96:97], v[44:45] op_sel_hi:[0,1]
    v_pk_fma_f32 v[98:99], v[96:97], v[44:45], v[98:99] op_sel:[1,1,0] op_sel_hi:[1,0,1] neg_lo:[0,1,0]
    v_cvt_pk_bf16_f32 v108, v96, v97
    ds_write_b32 v127, v108 offset:21120
    v_pk_mul_f32 v[40:41], v[96:97], v[28:29] op_sel_hi:[0,1]
    v_pk_fma_f32 v[40:41], v[96:97], v[28:29], v[40:41] op_sel:[1,1,0] op_sel_hi:[1,0,1] neg_lo:[0,1,0]
    v_cvt_pk_bf16_f32 v109, v40, v41
    ds_write_b32 v127, v109 offset:21648
    v_pk_mul_f32 v[102:103], v[100:101], v[44:45] op_sel_hi:[0,1]
    v_pk_fma_f32 v[102:103], v[100:101], v[44:45], v[102:103] op_sel:[1,1,0] op_sel_hi:[1,0,1] neg_lo:[0,1,0]
    v_cvt_pk_bf16_f32 v110, v100, v101
    ds_write_b32 v127, v110 offset:22176
    v_pk_mul_f32 v[42:43], v[100:101], v[28:29] op_sel_hi:[0,1]
    v_pk_fma_f32 v[42:43], v[100:101], v[28:29], v[42:43] op_sel:[1,1,0] op_sel_hi:[1,0,1] neg_lo:[0,1,0]
    v_cvt_pk_bf16_f32 v111, v42, v43
    ds_write_b32 v127, v111 offset:22704
    v_pk_mul_f32 v[96:97], v[98:99], v[44:45] op_sel_hi:[0,1]
    v_pk_fma_f32 v[96:97], v[98:99], v[44:45], v[96:97] op_sel:[1,1,0] op_sel_hi:[1,0,1] neg_lo:[0,1,0]
    v_cvt_pk_bf16_f32 v108, v98, v99
    ds_write_b32 v127, v108 offset:23232
    v_pk_mul_f32 v[40:41], v[98:99], v[28:29] op_sel_hi:[0,1]
    v_pk_fma_f32 v[40:41], v[98:99], v[28:29], v[40:41] op_sel:[1,1,0] op_sel_hi:[1,0,1] neg_lo:[0,1,0]
    v_cvt_pk_bf16_f32 v109, v40, v41
    ds_write_b32 v127, v109 offset:23760
    v_pk_mul_f32 v[100:101], v[102:103], v[44:45] op_sel_hi:[0,1]
    v_pk_fma_f32 v[100:101], v[102:103], v[44:45], v[100:101] op_sel:[1,1,0] op_sel_hi:[1,0,1] neg_lo:[0,1,0]
    v_cvt_pk_bf16_f32 v110, v102, v103
    ds_write_b32 v127, v110 offset:24288
    v_pk_mul_f32 v[42:43], v[102:103], v[28:29] op_sel_hi:[0,1]
    v_pk_fma_f32 v[42:43], v[102:103], v[28:29], v[42:43] op_sel:[1,1,0] op_sel_hi:[1,0,1] neg_lo:[0,1,0]
    v_cvt_pk_bf16_f32 v111, v42, v43
    ds_write_b32 v127, v111 offset:24816
    v_pk_mul_f32 v[98:99], v[96:97], v[44:45] op_sel_hi:[0,1]
    v_pk_fma_f32 v[98:99], v[96:97], v[44:45], v[98:99] op_sel:[1,1,0] op_sel_hi:[1,0,1] neg_lo:[0,1,0]
    v_cvt_pk_bf16_f32 v108, v96, v97
    ds_write_b32 v127, v108 offset:25344
    v_pk_mul_f32 v[102:103], v[100:101], v[44:45] op_sel_hi:[0,1]
    v_pk_fma_f32 v[102:103], v[100:101], v[44:45], v[102:103] op_sel:[1,1,0] op_sel_hi:[1,0,1] neg_lo:[0,1,0]
    v_cvt_pk_bf16_f32 v109, v100, v101
    ds_write_b32 v127, v109 offset:25872
    v_pk_mul_f32 v[96:97], v[98:99], v[44:45] op_sel_hi:[0,1]
    v_pk_fma_f32 v[96:97], v[98:99], v[44:45], v[96:97] op_sel:[1,1,0] op_sel_hi:[1,0,1] neg_lo:[0,1,0]
    v_cvt_pk_bf16_f32 v110, v98, v99
    ds_write_b32 v127, v110 offset:26400
    v_pk_mul_f32 v[100:101], v[102:103], v[44:45] op_sel_hi:[0,1]
    v_pk_fma_f32 v[100:101], v[102:103], v[44:45], v[100:101] op_sel:[1,1,0] op_sel_hi:[1,0,1] neg_lo:[0,1,0]
    v_cvt_pk_bf16_f32 v111, v102, v103
    ds_write_b32 v127, v111 offset:26928
    v_pk_mul_f32 v[98:99], v[96:97], v[44:45] op_sel_hi:[0,1]
    v_pk_fma_f32 v[98:99], v[96:97], v[44:45], v[98:99] op_sel:[1,1,0] op_sel_hi:[1,0,1] neg_lo:[0,1,0]
    v_cvt_pk_bf16_f32 v108, v96, v97
    ds_write_b32 v127, v108 offset:27456
    v_pk_mul_f32 v[102:103], v[100:101], v[44:45] op_sel_hi:[0,1]
    v_pk_fma_f32 v[102:103], v[100:101], v[44:45], v[102:103] op_sel:[1,1,0] op_sel_hi:[1,0,1] neg_lo:[0,1,0]
    v_cvt_pk_bf16_f32 v109, v100, v101
    ds_write_b32 v127, v109 offset:27984
    v_pk_mul_f32 v[96:97], v[98:99], v[44:45] op_sel_hi:[0,1]
    v_pk_fma_f32 v[96:97], v[98:99], v[44:45], v[96:97] op_sel:[1,1,0] op_sel_hi:[1,0,1] neg_lo:[0,1,0]
    v_cvt_pk_bf16_f32 v110, v98, v99
    ds_write_b32 v127, v110 offset:28512
    v_cvt_pk_bf16_f32 v111, v102, v103
    ds_write_b32 v127, v111 offset:29040
    v_cvt_pk_bf16_f32 v108, v96, v97
    ds_write_b32 v127, v108 offset:29568
    v_lshrrev_b32 v16, 4, v1
    v_and_b32 v16, 1, v16
    v_lshlrev_b32 v16, 2, v16
    v_and_b32 v17, 7, v1
    v_xor_b32 v16, v16, v17
    v_lshrrev_b32 v17, 3, v1
    v_lshlrev_b32 v17, 10, v17
    v_lshl_add_u32 v248, v16, 4, v17
    v_add_u32 v249, 15360, v248
    s_lshl_b32 s64, s36, 12
    s_mul_i32 s66, s36, 28
    s_add_u32 s66, s66, s67
    s_lshl_b32 s3, s66, 10
    s_lshl_b32 s66, s66, 14
    s_lshl_b32 s4, s39, 7
    s_add_u32 s66, s66, s4
    s_and_b32 s6, s36, 1
    s_lshr_b32 s7, s36, 1
    s_lshl_b32 s50, s38, 1
    s_add_u32 s50, s50, s6
    s_lshl_b32 s51, s39, 1
    s_add_u32 s51, s51, s7
    s_mul_i32 s52, s50, 114688
    s_xor_b32 s4, s50, 1
    s_mul_i32 s53, s4, 114688
    s_add_u32 s52, s52, s3
    s_add_u32 s53, s53, s3
    v_and_b32 v17, 16, v1
    v_lshlrev_b32 v18, 1, v17
    v_and_b32 v17, 1, v1
    v_lshl_add_u32 v18, v17, 4, v18
    v_and_b32 v17, 2, v1
    v_lshl_add_u32 v18, v17, 2, v18
    v_lshrrev_b32 v16, 2, v1
    v_and_b32 v16, 3, v16
    v_lshrrev_b32 v17, 5, v1
    v_lshl_add_u32 v19, v17, 2, v16
    v_lshl_add_u32 v8, v19, 7, v18
    v_lshrrev_b32 v16, 1, v16
    v_xor_b32 v16, s7, v16
    v_lshl_add_u32 v8, v16, 6, v8
    v_add_u32 v8, s64, v8
    v_xor_b32 v9, 64, v8
    v_add_u32 v10, 0x10000, v8
    v_add_u32 v11, 0x10000, v9
    v_add_u32 v12, 124160, v8
    v_add_u32 v13, 124160, v9
    v_lshlrev_b32 v5, 7, v1
    s_lshl_b32 s65, s38, 2
    s_add_u32 s65, s65, s36
    s_mul_i32 s65, s65, 1792
    s_add_u32 s65, s65, 11567104
    v_lshlrev_b32 v6, 4, v1
    v_and_b32 v32, 255, v0
    v_lshrrev_b32 v33, 3, v32
    v_lshlrev_b32 v217, 10, v33
    v_and_b32 v26, 7, v32
    v_lshl_add_u32 v217, v26, 4, v217
    v_xor_b32 v26, s2, v33
    v_and_b32 v26, 7, v26
    v_lshl_add_u32 v217, v26, 7, v217
    v_add_u32 v218, 32768, v217
    s_lshr_b32 s29, s2, 3
    s_lshl_b32 s29, s29, 16
    s_add_u32 s29, s29, 7340032
    s_and_b32 s3, s2, 31
    s_lshl_b32 s3, s3, 7
    s_add_u32 s3, s3, 11927552
    v_mov_b32 v252, s3
    v_lshlrev_b32 v216, 6, v33
    v_and_b32 v26, 3, v32
    v_lshl_add_u32 v216, v26, 4, v216
    v_bfe_u32 v26, v32, 2, 1
    v_mul_u32_u24 v26, 12928, v26
    v_add_u32 v216, v216, v26
    v_add_u32 v216, 107136, v216
    s_lshr_b32 s6, s36, 1
    s_and_b32 s7, s36, 1
    s_mul_i32 s5, s6, 12928
    s_add_u32 s5, s5, 98304
    v_and_b32 v26, 127, v0
    v_lshl_add_u32 v213, v26, 2, s5
    v_and_b32 v214, 60, v213
    s_mul_i32 s3, s7, 4160
    s_add_u32 s3, s3, s5
    v_add_u32 v214, s3, v214
    v_lshlrev_b32 v215, 4, v32
    v_add_u32 v215, 98304, v215
    v_lshlrev_b32 v29, 3, v32
    v_sub_u32 v29, 2047, v29
    v_cvt_f32_i32 v30, v29
    v_add_u32 v29, 17024, v29
    v_mov_b32 v31, 17152
    s_mov_b32 s3, 90400
    v_subrev_f32 v192, 0x00000000, v30
    v_cvt_pk_bf16_f32 v192, v192, 0
    v_subrev_u32 v24, 0, v29
    v_med3_i32 v192, v192, v24, v31
    v_lshl_add_u32 v192, v192, 2, s3
    v_subrev_f32 v193, 0x3f800000, v30
    v_cvt_pk_bf16_f32 v193, v193, 0
    v_subrev_u32 v24, 1, v29
    v_med3_i32 v193, v193, v24, v31
    v_lshl_add_u32 v193, v193, 2, s3
    v_subrev_f32 v194, 0x40000000, v30
    v_cvt_pk_bf16_f32 v194, v194, 0
    v_subrev_u32 v24, 2, v29
    v_med3_i32 v194, v194, v24, v31
    v_lshl_add_u32 v194, v194, 2, s3
    v_subrev_f32 v195, 0x40400000, v30
    v_cvt_pk_bf16_f32 v195, v195, 0
    v_subrev_u32 v24, 3, v29
    v_med3_i32 v195, v195, v24, v31
    v_lshl_add_u32 v195, v195, 2, s3
    v_subrev_f32 v196, 0x40800000, v30
    v_cvt_pk_bf16_f32 v196, v196, 0
    v_subrev_u32 v24, 4, v29
    v_med3_i32 v196, v196, v24, v31
    v_lshl_add_u32 v196, v196, 2, s3
    v_subrev_f32 v197, 0x40a00000, v30
    v_cvt_pk_bf16_f32 v197, v197, 0
    v_subrev_u32 v24, 5, v29
    v_med3_i32 v197, v197, v24, v31
    v_lshl_add_u32 v197, v197, 2, s3
    v_subrev_f32 v198, 0x40c00000, v30
    v_cvt_pk_bf16_f32 v198, v198, 0
    v_subrev_u32 v24, 6, v29
    v_med3_i32 v198, v198, v24, v31
    v_lshl_add_u32 v198, v198, 2, s3
    v_subrev_f32 v199, 0x40e00000, v30
    v_cvt_pk_bf16_f32 v199, v199, 0
    v_subrev_u32 v24, 7, v29
    v_med3_i32 v199, v199, v24, v31
    v_lshl_add_u32 v199, v199, 2, s3
    v_subrev_f32 v200, 0x41000000, v30
    v_cvt_pk_bf16_f32 v200, v200, 0
    v_subrev_u32 v24, 8, v29
    v_med3_i32 v200, v200, v24, v31
    v_lshl_add_u32 v200, v200, 2, s3
    s_lshr_b32 s6, s36, 1
    s_and_b32 s7, s36, 1
    s_mul_i32 s4, s6, 30096
    s_add_u32 s4, s4, 98304
    v_and_b32 v16, 15, v1
    v_lshrrev_b32 v17, 4, v1
    v_mul_u32_u24 v219, 528, v16
    v_lshl_add_u32 v219, v17, 4, v219
    v_add_u32 v219, s4, v219
    s_mul_i32 s4, s7, 8448
    v_add_u32 v220, s4, v219
    s_lshl_b32 s3, s6, 1
    s_add_u32 s3, s3, 158496
    v_lshrrev_b32 v18, 1, v17
    v_and_b32 v19, 1, v17
    v_lshlrev_b32 v24, 7, v18
    v_lshl_add_u32 v24, v19, 2, v24
    v_lshl_add_u32 v24, v16, 3, v24
    v_lshlrev_b32 v25, 6, v17
    v_add_u32 v25, 256, v25
    v_lshl_add_u32 v26, v16, 2, v25
    v_lshl_add_u32 v27, v16, 1, v25
    v_cmp_gt_u32 vcc, 2, v17
    v_mov_b32 v28, 32
    v_lshl_add_u32 v25, v17, 6, v16
    v_cndmask_b32 v26, v27, v26, vcc
    v_cndmask_b32 v28, v28, 2, vcc
    s_cmp_eq_u32 s7, 0
    s_cselect_b64 vcc, -1, 0
    v_lshl_add_u32 v223, v25, 2, s3
    v_cndmask_b32 v26, v26, v24, vcc
    v_cndmask_b32 v28, v28, 2, vcc
    v_add_u32 v28, v26, v28
    v_lshl_add_u32 v221, v26, 2, s3
    v_lshl_add_u32 v222, v28, 2, s3
    s_waitcnt lgkmcnt(0)
    s_lshl_b32 s3, s48, 16
    s_and_b32 s4, s48, 0xffff0000
    s_cmp_lt_u32 s36, 2
    s_cselect_b32 s3, s3, s4
    s_and_b32 s4, s36, 1
    s_cmp_eq_u32 s4, 0
    s_cselect_b32 s3, s3, 0
    v_mov_b32 v232, 0
    v_writelane_b32 v232, s3, 0
    v_mov_b32 v233, 161572
    s_waitcnt vmcnt(0)
    ds_write_b128 v132, v[128:131]
    s_branch L_mv_common
L_mv_a:
    s_sub_u32 s6, s2, 224
    s_lshl_b32 s3, s6, 2
    s_add_u32 s3, s3, s24
    s_mul_i32 s3, s3, 22
    v_add_u32 v16, s3, v1
    s_add_u32 s3, s6, 2816
    v_mov_b32 v17, s3
    v_cmp_gt_u32 vcc, 22, v1
    s_getpc_b64 s[4:5]
L_pc:
    s_sub_u32 s4, s4, L_pc - gated_mix__ssm_conv_s4__geglu_ffn__prompt_kernel
    s_subb_u32 s5, s5, 0
    v_cndmask_b32 v16, v17, v16, vcc
    v_lshlrev_b32 v16, 7, v16
    v_add_u32 v16, 11567104, v16
    buffer_store_dword v251, v16, s[20:23], 0 offen sc1
    v_lshlrev_b32 v16, 7, v0
    v_min_u32 v16, L_exit - gated_mix__ssm_conv_s4__geglu_ffn__prompt_kernel, v16
    global_load_dword v76, v16, s[4:5]
    s_waitcnt vmcnt(2)
    s_branch L_a_tab
L_mv_a2:
    s_waitcnt vmcnt(0)
    s_mov_b64 exec, 1
    global_atomic_add v15, v14, s[62:63] sc1
    s_mov_b64 exec, -1
L_mv_common:
    s_sub_u32 s40, s2, 224
    v_and_b32 v2, 15, v1
    v_lshrrev_b32 v3, 4, v1
    v_lshlrev_b32 v16, 4, v3
    v_lshrrev_b32 v17, 2, v1
    v_and_b32 v17, 3, v17
    v_lshl_add_u32 v17, v3, 3, v17
    v_mul_u32_u24 v17, 1056, v17
    v_and_b32 v18, 3, v1
    v_lshl_add_u32 v17, v18, 3, v17
    s_lshl_b32 s4, s24, 7
    v_add_u32 v17, s4, v17
    s_lshl_b32 s3, s24, 18
    s_lshl_b32 s4, s40, 11
    s_add_u32 s3, s3, s4
    s_add_u32 s3, s3, 7340032
    v_lshlrev_b32 v18, 6, v2
    v_lshl_add_u32 v18, v3, 4, v18
    s_and_b32 s4, s40, 3
    s_lshl_b32 s4, s4, 8
    v_xor_b32 v18, s4, v18
    v_xor_b32 v19, 128, v18
    s_waitcnt lgkmcnt(0)
    s_barrier
    ds_read_b64_tr_b16 v[160:161], v17 offset:0
    ds_read_b64_tr_b16 v[162:163], v17 offset:4224
    ds_read_b64_tr_b16 v[164:165], v17 offset:33792
    ds_read_b64_tr_b16 v[166:167], v17 offset:38016
    ds_read_b64_tr_b16 v[168:169], v17 offset:32
    ds_read_b64_tr_b16 v[170:171], v17 offset:4256
    ds_read_b64_tr_b16 v[172:173], v17 offset:33824
    ds_read_b64_tr_b16 v[174:175], v17 offset:38048
    ds_read_b64_tr_b16 v[176:177], v17 offset:64
    ds_read_b64_tr_b16 v[178:179], v17 offset:4288
    ds_read_b64_tr_b16 v[180:181], v17 offset:33856
    ds_read_b64_tr_b16 v[182:183], v17 offset:38080
    ds_read_b64_tr_b16 v[184:185], v17 offset:96
    ds_read_b64_tr_b16 v[186:187], v17 offset:4320
    ds_read_b64_tr_b16 v[188:189], v17 offset:33888
    ds_read_b64_tr_b16 v[190:191], v17 offset:38112
    s_waitcnt lgkmcnt(12)
    buffer_store_dwordx4 v[160:163], v18, s[20:23], s3 offen sc1
    buffer_store_dwordx4 v[164:167], v19, s[20:23], s3 offen offset:1024 sc1
    s_add_u32 s3, s3, 65536
    s_waitcnt lgkmcnt(8)
    buffer_store_dwordx4 v[168:171], v18, s[20:23], s3 offen sc1
    buffer_store_dwordx4 v[172:175], v19, s[20:23], s3 offen offset:1024 sc1
    s_add_u32 s3, s3, 65536
    s_waitcnt lgkmcnt(4)
    buffer_store_dwordx4 v[176:179], v18, s[20:23], s3 offen sc1
    buffer_store_dwordx4 v[180:183], v19, s[20:23], s3 offen offset:1024 sc1
    s_add_u32 s3, s3, 65536
    s_waitcnt lgkmcnt(0)
    buffer_store_dwordx4 v[184:187], v18, s[20:23], s3 offen sc1
    buffer_store_dwordx4 v[188:191], v19, s[20:23], s3 offen offset:1024 sc1
    s_add_u32 s3, s3, 65536
    s_cmp_eq_u32 s100, 0
    s_cbranch_scc1 L_mv_a3
    s_mul_i32 s4, s36, 16896
    v_mul_u32_u24 v17, 1056, v2
    v_add_u32 v17, v17, v16
    v_add_u32 v17, s4, v17
    v_add_u32 v4, 67584, v16
    ds_read_b128 v[32:35], v17 offset:0
    ds_read_b128 v[96:99], v4 offset:0
    ds_read_b128 v[36:39], v17 offset:64
    ds_read_b128 v[100:103], v4 offset:64
    ds_read_b128 v[40:43], v17 offset:128
    ds_read_b128 v[104:107], v4 offset:128
    ds_read_b128 v[44:47], v17 offset:192
    ds_read_b128 v[108:111], v4 offset:192
    ds_read_b128 v[48:51], v17 offset:256
    ds_read_b128 v[112:115], v4 offset:256
    ds_read_b128 v[52:55], v17 offset:320
    ds_read_b128 v[116:119], v4 offset:320
    ds_read_b128 v[56:59], v17 offset:384
    ds_read_b128 v[120:123], v4 offset:384
    ds_read_b128 v[60:63], v17 offset:448
    ds_read_b128 v[124:127], v4 offset:448
    ds_read_b128 v[64:67], v17 offset:512
    ds_read_b128 v[128:131], v4 offset:512
    ds_read_b128 v[68:71], v17 offset:576
    ds_read_b128 v[132:135], v4 offset:576
    ds_read_b128 v[72:75], v17 offset:640
    ds_read_b128 v[136:139], v4 offset:640
    ds_read_b128 v[76:79], v17 offset:704
    ds_read_b128 v[140:143], v4 offset:704
    ds_read_b128 v[80:83], v17 offset:768
    ds_read_b128 v[144:147], v4 offset:768
    ds_read_b128 v[84:87], v17 offset:832
    ds_read_b128 v[148:151], v4 offset:832
    ds_read_b128 v[88:91], v17 offset:896
    ds_read_b128 v[152:155], v4 offset:896
    ds_read_b128 v[92:95], v17 offset:960
    ds_read_b128 v[156:159], v4 offset:960
    s_waitcnt lgkmcnt(0)
    v_mfma_f32_16x16x32_bf16 v[24:27], v[32:35], v[96:99], 0
    v_mfma_f32_16x16x32_bf16 v[28:31], v[36:39], v[100:103], 0
    v_mfma_f32_16x16x32_bf16 v[24:27], v[40:43], v[104:107], v[24:27]
    v_mfma_f32_16x16x32_bf16 v[28:31], v[44:47], v[108:111], v[28:31]
    v_mfma_f32_16x16x32_bf16 v[24:27], v[48:51], v[112:115], v[24:27]
    v_mfma_f32_16x16x32_bf16 v[28:31], v[52:55], v[116:119], v[28:31]
    v_mfma_f32_16x16x32_bf16 v[24:27], v[56:59], v[120:123], v[24:27]
    v_mfma_f32_16x16x32_bf16 v[28:31], v[60:63], v[124:127], v[28:31]
    v_mfma_f32_16x16x32_bf16 v[24:27], v[64:67], v[128:131], v[24:27]
    v_mfma_f32_16x16x32_bf16 v[28:31], v[68:71], v[132:135], v[28:31]
    v_mfma_f32_16x16x32_bf16 v[24:27], v[72:75], v[136:139], v[24:27]
    v_mfma_f32_16x16x32_bf16 v[28:31], v[76:79], v[140:143], v[28:31]
    v_mfma_f32_16x16x32_bf16 v[24:27], v[80:83], v[144:147], v[24:27]
    v_mfma_f32_16x16x32_bf16 v[28:31], v[84:87], v[148:151], v[28:31]
    v_mfma_f32_16x16x32_bf16 v[24:27], v[88:91], v[152:155], v[24:27]
    v_mfma_f32_16x16x32_bf16 v[28:31], v[92:95], v[156:159], v[28:31]
    s_lshl_b32 s3, s40, 2
    s_add_u32 s3, s3, s36
    s_lshl_b32 s3, s3, 6
    s_add_u32 s3, s3, 11534336
    s_nop 5
    v_add_f32 v24, v24, v28
    v_add_f32 v25, v25, v29
    v_add_f32 v26, v26, v30
    v_add_f32 v27, v27, v31
    v_cvt_pk_bf16_f32 v24, 0, v24
    v_cvt_pk_bf16_f32 v25, 0, v25
    v_cvt_pk_bf16_f32 v26, 0, v26
    v_cvt_pk_bf16_f32 v27, 0, v27
    v_mul_f32 v24, 0xbfb8aa3b, v24
    v_mul_f32 v25, 0xbfb8aa3b, v25
    v_mul_f32 v26, 0xbfb8aa3b, v26
    v_mul_f32 v27, 0xbfb8aa3b, v27
    v_exp_f32 v24, v24
    v_exp_f32 v25, v25
    v_exp_f32 v26, v26
    v_exp_f32 v27, v27
    s_nop 0
    v_add_f32 v24, 1.0, v24
    v_add_f32 v25, 1.0, v25
    v_add_f32 v26, 1.0, v26
    v_add_f32 v27, 1.0, v27
    v_rcp_f32 v24, v24
    v_rcp_f32 v25, v25
    v_rcp_f32 v26, v26
    v_rcp_f32 v27, v27
    s_nop 0
    v_cvt_pk_bf16_f32 v24, 0, v24
    v_cvt_pk_bf16_f32 v25, 0, v25
    v_cvt_pk_bf16_f32 v26, 0, v26
    v_cvt_pk_bf16_f32 v27, 0, v27
    v_sub_f32 v28, 1.0, v24
    v_sub_f32 v29, 1.0, v25
    v_sub_f32 v30, 1.0, v26
    v_sub_f32 v31, 1.0, v27
    v_cvt_pk_bf16_f32 v24, v24, v28
    v_cvt_pk_bf16_f32 v25, v25, v29
    v_cvt_pk_bf16_f32 v26, v26, v30
    v_cvt_pk_bf16_f32 v27, v27, v31
    v_cmp_eq_u32 vcc, 0, v2
    s_and_saveexec_b64 s[4:5], vcc
    buffer_store_dwordx4 v[24:27], v16, s[20:23], s3 offen sc1
    s_mov_b64 exec, s[4:5]
    ds_read_b128 v[48:51], v219 offset:0
    ds_read_b128 v[52:55], v220 offset:8448
    ds_read_b128 v[56:59], v219 offset:25344
    ds_read_b128 v[60:63], v219 offset:64
    ds_read_b128 v[64:67], v220 offset:8512
    ds_read_b128 v[68:71], v219 offset:25408
    ds_read_b128 v[72:75], v219 offset:128
    ds_read_b128 v[76:79], v220 offset:8576
    ds_read_b128 v[80:83], v219 offset:25472
    ds_read_b128 v[84:87], v219 offset:192
    ds_read_b128 v[88:91], v220 offset:8640
    ds_read_b128 v[92:95], v219 offset:25536
    ds_read_b128 v[96:99], v219 offset:256
    ds_read_b128 v[100:103], v220 offset:8704
    ds_read_b128 v[104:107], v219 offset:25600
    ds_read_b128 v[108:111], v219 offset:320
    ds_read_b128 v[112:115], v220 offset:8768
    ds_read_b128 v[116:119], v219 offset:25664
    ds_read_b128 v[120:123], v219 offset:384
    ds_read_b128 v[124:127], v220 offset:8832
    ds_read_b128 v[128:131], v219 offset:25728
    ds_read_b128 v[132:135], v219 offset:448
    ds_read_b128 v[136:139], v220 offset:8896
    ds_read_b128 v[140:143], v219 offset:25792
    s_waitcnt vmcnt(0) lgkmcnt(0)
    s_barrier
    s_cmp_eq_u32 s24, 4
    s_cbranch_scc0 L_pi2_ok
    s_mov_b64 exec, 1
    global_atomic_add v40, v251, v253, s[62:63] offset:128 sc0 sc1
    s_mov_b64 exec, -1
    global_load_dword v250, v251, s[62:63] sc1
    s_waitcnt vmcnt(0)
    v_readfirstlane_b32 s3, v40
    v_and_b32 v17, 31, v1
    v_lshlrev_b32 v17, 7, v17
    v_add_u32 v17, 11927552, v17
    s_and_b32 s3, s3, 31
    s_cmp_eq_u32 s3, 31
    s_cbranch_scc0 L_pi2
    buffer_store_dword v253, v17, s[20:23], 0 offen sc1
L_pi2:
    v_cmp_gt_u32 vcc, 128, v250
    s_cbranch_vccz L_pi2_ok
    s_sub_u32 s42, s42, 1
    s_cmp_lt_i32 s42, 0
    s_cbranch_scc1 L_pi2_ok
    s_sleep 8
    global_load_dword v250, v251, s[62:63] sc1
    s_waitcnt vmcnt(0)
    s_branch L_pi2
L_pi2_ok:
    s_add_u32 m0, s64, 0
    s_add_u32 s41, s66, 0
    buffer_load_dwordx4 v248, s[68:71], s41 offen lds
    buffer_load_dwordx4 v249, s[68:71], s41 offen offset:1024 lds
    s_add_u32 m0, s64, 2048
    s_add_u32 s41, s66, 8192
    buffer_load_dwordx4 v248, s[68:71], s41 offen lds
    buffer_load_dwordx4 v249, s[68:71], s41 offen offset:1024 lds
    s_add_u32 m0, s64, 65536
    s_cmp_ge_u32 s67, 20
    s_cselect_b32 s47, 458752, 0
    s_add_u32 s41, s66, 131072
    s_sub_u32 s41, s41, s47
    buffer_load_dwordx4 v248, s[68:71], s41 offen lds
    buffer_load_dwordx4 v249, s[68:71], s41 offen offset:1024 lds
    s_add_u32 m0, s64, 67584
    s_cmp_ge_u32 s67, 19
    s_cselect_b32 s47, 458752, 0
    s_add_u32 s41, s66, 139264
    s_sub_u32 s41, s41, s47
    buffer_load_dwordx4 v248, s[68:71], s41 offen lds
    buffer_load_dwordx4 v249, s[68:71], s41 offen offset:1024 lds
    s_add_u32 m0, s64, 16384
    s_add_u32 s41, s66, 32768
    buffer_load_dwordx4 v248, s[68:71], s41 offen lds
    buffer_load_dwordx4 v249, s[68:71], s41 offen offset:1024 lds
    s_add_u32 m0, s64, 18432
    s_add_u32 s41, s66, 40960
    buffer_load_dwordx4 v248, s[68:71], s41 offen lds
    buffer_load_dwordx4 v249, s[68:71], s41 offen offset:1024 lds
    s_add_u32 m0, s64, 32768
    s_cmp_ge_u32 s67, 24
    s_cselect_b32 s47, 458752, 0
    s_add_u32 s41, s66, 65536
    s_sub_u32 s41, s41, s47
    buffer_load_dwordx4 v248, s[68:71], s41 offen lds
    buffer_load_dwordx4 v249, s[68:71], s41 offen offset:1024 lds
    s_add_u32 m0, s64, 34816
    s_cmp_ge_u32 s67, 23
    s_cselect_b32 s47, 458752, 0
    s_add_u32 s41, s66, 73728
    s_sub_u32 s41, s41, s47
    buffer_load_dwordx4 v248, s[68:71], s41 offen lds
    buffer_load_dwordx4 v249, s[68:71], s41 offen offset:1024 lds
    s_add_u32 m0, s64, 81920
    s_cmp_ge_u32 s67, 18
    s_cselect_b32 s47, 458752, 0
    s_add_u32 s41, s66, 163840
    s_sub_u32 s41, s41, s47
    buffer_load_dwordx4 v248, s[68:71], s41 offen lds
    buffer_load_dwordx4 v249, s[68:71], s41 offen offset:1024 lds
    s_add_u32 m0, s64, 83968
    s_cmp_ge_u32 s67, 17
    s_cselect_b32 s47, 458752, 0
    s_add_u32 s41, s66, 172032
    s_sub_u32 s41, s41, s47
    buffer_load_dwordx4 v248, s[68:71], s41 offen lds
    buffer_load_dwordx4 v249, s[68:71], s41 offen offset:1024 lds
    s_add_u32 m0, s64, 49152
    s_cmp_ge_u32 s67, 22
    s_cselect_b32 s47, 458752, 0
    s_add_u32 s41, s66, 98304
    s_sub_u32 s41, s41, s47
    buffer_load_dwordx4 v248, s[68:71], s41 offen lds
    buffer_load_dwordx4 v249, s[68:71], s41 offen offset:1024 lds
    s_add_u32 m0, s64, 51200
    s_cmp_ge_u32 s67, 21
    s_cselect_b32 s47, 458752, 0
    s_add_u32 s41, s66, 106496
    s_sub_u32 s41, s41, s47
    buffer_load_dwordx4 v248, s[68:71], s41 offen lds
    buffer_load_dwordx4 v249, s[68:71], s41 offen offset:1024 lds
    s_add_u32 m0, s64, 124160
    s_cmp_ge_u32 s67, 4
    s_cselect_b32 s47, 458752, 0
    s_add_u32 s41, s66, 393216
    s_sub_u32 s41, s41, s47
    buffer_load_dwordx4 v248, s[68:71], s41 offen lds
    buffer_load_dwordx4 v249, s[68:71], s41 offen offset:1024 lds
    s_add_u32 m0, s64, 126208
    s_cmp_ge_u32 s67, 3
    s_cselect_b32 s47, 458752, 0
    s_add_u32 s41, s66, 401408
    s_sub_u32 s41, s41, s47
    buffer_load_dwordx4 v248, s[68:71], s41 offen lds
    buffer_load_dwordx4 v249, s[68:71], s41 offen offset:1024 lds
    s_add_u32 m0, s64, 140544
    s_cmp_ge_u32 s67, 2
    s_cselect_b32 s47, 458752, 0
    s_add_u32 s41, s66, 425984
    s_sub_u32 s41, s41, s47
    buffer_load_dwordx4 v248, s[68:71], s41 offen lds
    buffer_load_dwordx4 v249, s[68:71], s41 offen offset:1024 lds
    s_add_u32 m0, s64, 142592
    s_cmp_ge_u32 s67, 1
    s_cselect_b32 s47, 458752, 0
    s_add_u32 s41, s66, 434176
    s_sub_u32 s41, s41, s47
    buffer_load_dwordx4 v248, s[68:71], s41 offen lds
    buffer_load_dwordx4 v249, s[68:71], s41 offen offset:1024 lds
    s_barrier
    buffer_load_dword v250, v252, s[20:23], 0 offen sc1
    v_mfma_f32_16x16x32_bf16 v[176:179], v[52:55], v[48:51], 0
    v_mfma_f32_16x16x32_bf16 v[180:183], v[56:59], v[48:51], 0
    v_mfma_f32_16x16x32_bf16 v[176:179], v[64:67], v[60:63], v[176:179]
    v_mfma_f32_16x16x32_bf16 v[180:183], v[68:71], v[60:63], v[180:183]
    v_mfma_f32_16x16x32_bf16 v[176:179], v[76:79], v[72:75], v[176:179]
    v_mfma_f32_16x16x32_bf16 v[180:183], v[80:83], v[72:75], v[180:183]
    v_mfma_f32_16x16x32_bf16 v[176:179], v[88:91], v[84:87], v[176:179]
    v_mfma_f32_16x16x32_bf16 v[180:183], v[92:95], v[84:87], v[180:183]
    v_mfma_f32_16x16x32_bf16 v[176:179], v[100:103], v[96:99], v[176:179]
    v_mfma_f32_16x16x32_bf16 v[180:183], v[104:107], v[96:99], v[180:183]
    v_mfma_f32_16x16x32_bf16 v[176:179], v[112:115], v[108:111], v[176:179]
    v_mfma_f32_16x16x32_bf16 v[180:183], v[116:119], v[108:111], v[180:183]
    v_mfma_f32_16x16x32_bf16 v[176:179], v[124:127], v[120:123], v[176:179]
    v_mfma_f32_16x16x32_bf16 v[180:183], v[128:131], v[120:123], v[180:183]
    v_mfma_f32_16x16x32_bf16 v[176:179], v[136:139], v[132:135], v[176:179]
    v_mfma_f32_16x16x32_bf16 v[180:183], v[140:143], v[132:135], v[180:183]
    s_waitcnt vmcnt(0)
L_pm2:
    v_cmp_gt_u32 vcc, 1, v250
    s_cbranch_vccz L_pm2_ok
    s_sub_u32 s42, s42, 1
    s_cmp_lt_i32 s42, 0
    s_cbranch_scc1 L_pm2_ok
    s_sleep 8
    buffer_load_dword v250, v252, s[20:23], 0 offen sc1
    s_waitcnt vmcnt(0)
    s_branch L_pm2
L_pm2_ok:
    buffer_load_dwordx4 v[224:227], v217, s[20:23], s29 offen sc1
    buffer_load_dwordx4 v[228:231], v218, s[20:23], s29 offen sc1
    s_nop 7
    v_add_f32 v176, v176, v232
    v_cvt_pk_bf16_f32 v184, v176, v177
    v_cvt_pk_bf16_f32 v185, v178, v179
    v_cvt_pk_bf16_f32 v186, v180, v181
    v_cvt_pk_bf16_f32 v187, v182, v183
    ds_write_b16 v221, v184
    ds_write_b16_d16_hi v221, v184 offset:4
    ds_write_b16 v222, v185
    ds_write_b16_d16_hi v222, v185 offset:4
    ds_write_b16 v223, v186 offset:2048
    ds_write_b16_d16_hi v223, v186 offset:2112
    ds_write_b16 v223, v187 offset:2176
    ds_write_b16_d16_hi v223, v187 offset:2240
    s_mov_b64 exec, 1
    s_waitcnt lgkmcnt(0)
    ds_add_u32 v233, v253
    s_mov_b64 exec, -1
    ds_read_b64_tr_b16 v[48:49], v8 offset:0
    ds_read_b64_tr_b16 v[50:51], v8 offset:1024
    ds_read_b64_tr_b16 v[52:53], v9 offset:0
    ds_read_b64_tr_b16 v[54:55], v9 offset:1024
    ds_read_b64_tr_b16 v[56:57], v8 offset:2048
    ds_read_b64_tr_b16 v[58:59], v8 offset:3072
    ds_read_b64_tr_b16 v[60:61], v9 offset:2048
    ds_read_b64_tr_b16 v[62:63], v9 offset:3072
    s_waitcnt lgkmcnt(0)
    ds_read_b64_tr_b16 v[64:65], v10 offset:0
    ds_read_b64_tr_b16 v[66:67], v10 offset:1024
    ds_read_b64_tr_b16 v[68:69], v11 offset:0
    ds_read_b64_tr_b16 v[70:71], v11 offset:1024
    ds_read_b64_tr_b16 v[72:73], v10 offset:2048
    ds_read_b64_tr_b16 v[74:75], v10 offset:3072
    ds_read_b64_tr_b16 v[76:77], v11 offset:2048
    ds_read_b64_tr_b16 v[78:79], v11 offset:3072
    s_waitcnt lgkmcnt(0)
    s_mov_b64 exec, 1
L_pm2_k:
    ds_read_b32 v2, v233
    s_waitcnt lgkmcnt(0)
    v_cmp_gt_u32 vcc, 4, v2
    s_cbranch_vccz L_pm2_kgo
    s_sub_u32 s42, s42, 1
    s_cmp_lt_i32 s42, 0
    s_cbranch_scc0 L_pm2_k
L_pm2_kgo:
    s_mov_b64 exec, -1
    ds_read_b32 v204, v192
    ds_read_b32 v205, v193
    ds_read_b32 v206, v194
    ds_read_b32 v207, v195
    ds_read_b32 v208, v196
    ds_read_b32 v209, v197
    ds_read_b32 v210, v198
    ds_read_b32 v211, v199
    ds_read_b32 v212, v200
    ds_read_b64_tr_b16 v[80:81], v8 offset:16384
    ds_read_b64_tr_b16 v[82:83], v8 offset:17408
    ds_read_b64_tr_b16 v[84:85], v9 offset:16384
    ds_read_b64_tr_b16 v[86:87], v9 offset:17408
    ds_read_b64_tr_b16 v[88:89], v8 offset:18432
    ds_read_b64_tr_b16 v[90:91], v8 offset:19456
    ds_read_b64_tr_b16 v[92:93], v9 offset:18432
    ds_read_b64_tr_b16 v[94:95], v9 offset:19456
    ds_read_b64_tr_b16 v[96:97], v8 offset:32768
    ds_read_b64_tr_b16 v[98:99], v8 offset:33792
    ds_read_b64_tr_b16 v[100:101], v9 offset:32768
    ds_read_b64_tr_b16 v[102:103], v9 offset:33792
    ds_read_b64_tr_b16 v[104:105], v8 offset:34816
    ds_read_b64_tr_b16 v[106:107], v8 offset:35840
    ds_read_b64_tr_b16 v[108:109], v9 offset:34816
    ds_read_b64_tr_b16 v[110:111], v9 offset:35840
    s_waitcnt lgkmcnt(0)
    ds_read_b64_tr_b16 v[144:145], v12 offset:0
    ds_read_b64_tr_b16 v[146:147], v12 offset:1024
    ds_read_b64_tr_b16 v[148:149], v13 offset:0
    ds_read_b64_tr_b16 v[150:151], v13 offset:1024
    ds_read_b64_tr_b16 v[152:153], v12 offset:2048
    ds_read_b64_tr_b16 v[154:155], v12 offset:3072
    ds_read_b64_tr_b16 v[156:157], v13 offset:2048
    ds_read_b64_tr_b16 v[158:159], v13 offset:3072
    ds_read_b64_tr_b16 v[160:161], v12 offset:16384
    ds_read_b64_tr_b16 v[162:163], v12 offset:17408
    ds_read_b64_tr_b16 v[164:165], v13 offset:16384
    ds_read_b64_tr_b16 v[166:167], v13 offset:17408
    ds_read_b64_tr_b16 v[168:169], v12 offset:18432
    ds_read_b64_tr_b16 v[170:171], v12 offset:19456
    ds_read_b64_tr_b16 v[172:173], v13 offset:18432
    ds_read_b64_tr_b16 v[174:175], v13 offset:19456
    v_cmp_ne_u32 vcc, 0x1ff, v0
    ds_write_b32 v213, v251 offset:8320
    ds_write_b32 v214, v251 offset:4096
    v_cndmask_b32 v212, 0, v212, vcc
    s_mov_b32 s54, 0x05040100
    s_mov_b32 s55, 0x07060302
    v_perm_b32 v16, v205, v204, s54
    v_perm_b32 v17, v207, v206, s54
    v_perm_b32 v18, v209, v208, s54
    v_perm_b32 v19, v211, v210, s54
    ds_write_b128 v215, v[16:19] offset:0
    v_perm_b32 v20, v206, v205, s54
    v_perm_b32 v21, v208, v207, s54
    v_perm_b32 v22, v210, v209, s54
    v_perm_b32 v23, v212, v211, s54
    ds_write_b128 v215, v[20:23] offset:4160
    v_perm_b32 v24, v205, v204, s55
    v_perm_b32 v25, v207, v206, s55
    v_perm_b32 v26, v209, v208, s55
    v_perm_b32 v27, v211, v210, s55
    ds_write_b128 v215, v[24:27] offset:12928
    v_perm_b32 v28, v206, v205, s55
    v_perm_b32 v29, v208, v207, s55
    v_perm_b32 v30, v210, v209, s55
    v_perm_b32 v31, v212, v211, s55
    ds_write_b128 v215, v[28:31] offset:17088
    ds_read_b64_tr_b16 v[112:113], v10 offset:16384
    ds_read_b64_tr_b16 v[114:115], v10 offset:17408
    ds_read_b64_tr_b16 v[116:117], v11 offset:16384
    ds_read_b64_tr_b16 v[118:119], v11 offset:17408
    ds_read_b64_tr_b16 v[120:121], v10 offset:18432
    ds_read_b64_tr_b16 v[122:123], v10 offset:19456
    ds_read_b64_tr_b16 v[124:125], v11 offset:18432
    ds_read_b64_tr_b16 v[126:127], v11 offset:19456
    ds_read_b64_tr_b16 v[128:129], v8 offset:49152
    ds_read_b64_tr_b16 v[130:131], v8 offset:50176
    ds_read_b64_tr_b16 v[132:133], v9 offset:49152
    ds_read_b64_tr_b16 v[134:135], v9 offset:50176
    ds_read_b64_tr_b16 v[136:137], v8 offset:51200
    ds_read_b64_tr_b16 v[138:139], v8 offset:52224
    ds_read_b64_tr_b16 v[140:141], v9 offset:51200
    ds_read_b64_tr_b16 v[142:143], v9 offset:52224
    s_waitcnt lgkmcnt(0)
    s_waitcnt vmcnt(0)
    ds_write_b128 v216, v[224:227]
    ds_write_b128 v216, v[228:231] offset:2048
    s_branch L_b_join
L_mv_a3:
    s_lshr_b32 s47, s40, 3
    s_mul_i32 s47, s47, 458752
    s_lshl_b32 s4, s24, 13
    s_add_u32 s47, s47, s4
    s_lshl_b32 s46, s67, 14
    s_add_u32 s46, s46, 196608
    v_lshlrev_b32 v77, 7, v1
    s_waitcnt vmcnt(0) lgkmcnt(0)
    s_barrier
    s_barrier
    s_cmp_ge_u32 s46, 458752
    s_cselect_b32 s3, 458752, 0
    s_sub_u32 s46, s46, s3
    s_add_u32 s3, s47, s46
    buffer_load_dword v76, v77, s[68:71], s3 offen
    s_add_u32 s46, s46, 32768
    s_cmp_ge_u32 s46, 458752
    s_cselect_b32 s3, 458752, 0
    s_sub_u32 s46, s46, s3
    s_add_u32 s3, s47, s46
    buffer_load_dword v76, v77, s[68:71], s3 offen
    s_add_u32 s46, s46, 32768
    s_cmp_ge_u32 s46, 458752
    s_cselect_b32 s3, 458752, 0
    s_sub_u32 s46, s46, s3
    s_add_u32 s3, s47, s46
    buffer_load_dword v76, v77, s[68:71], s3 offen
    s_add_u32 s46, s46, 32768
    s_lshr_b32 s6, s36, 1
    s_and_b32 s7, s36, 1
    s_mul_i32 s5, s6, 12928
    s_add_u32 s5, s5, 98304
    v_and_b32 v60, 15, v1
    v_lshrrev_b32 v61, 4, v1
    v_and_b32 v62, 1, v60
    v_xor_b32 v62, 1, v62
    v_mul_u32_u24 v62, 4160, v62
    v_and_b32 v63, 14, v60
    v_lshlrev_b32 v63, 1, v63
    v_sub_u32 v62, v62, v63
    v_lshl_add_u32 v62, v61, 4, v62
    s_lshl_b32 s4, s7, 8
    s_sub_u32 s4, s5, s4
    s_add_u32 s3, s4, 3356
    v_add_u32 v48, s3, v62
    v_subrev_u32 v49, 1024, v48
    v_subrev_u32 v50, 2048, v48
    v_subrev_u32 v51, 3072, v48
    v_lshlrev_b32 v52, 5, v60
    v_lshl_add_u32 v52, v61, 4, v52
    s_add_u32 s3, s4, 8608
    v_add_u32 v52, s3, v52
    v_lshlrev_b32 v53, 6, v60
    v_lshl_add_u32 v53, v61, 4, v53
    s_lshl_b32 s3, s36, 13
    s_add_u32 s3, s3, 124160
    v_add_u32 v53, s3, v53
    v_lshlrev_b32 v56, 4, v0
    v_add_u32 v57, 4096, v56
    v_add_u32 v54, 124160, v56
    v_mov_b32 v58, 161568
    v_and_b32 v62, 2, v61
    v_and_b32 v63, 1, v61
    v_lshl_or_b32 v62, v62, 2, v63
    v_xor_b32 v62, v62, v1
    v_lshl_add_u32 v53, v62, 4, s3
    v_and_b32 v62, 2, v1
    v_and_b32 v63, 1, v1
    v_lshl_or_b32 v62, v62, 2, v63
    v_lshrrev_b32 v63, 2, v1
    v_xor_b32 v62, v62, v63
    v_and_b32 v63, 3, v1
    v_lshl_add_u32 v62, v63, 4, v62
    s_lshl_b32 s3, s36, 10
    s_add_u32 s3, s3, 124160
    v_lshl_add_u32 v54, v62, 4, s3
    s_mov_b32 s31, 0x40000000
    s_branch L_a_join
L_exit:
    s_endpgm
.section .rodata,"a"
.p2align 6
.amdhsa_kernel gated_mix__ssm_conv_s4__geglu_ffn__prompt_kernel
.amdhsa_next_free_vgpr 256
.amdhsa_next_free_sgpr 102
.amdhsa_accum_offset 256
.amdhsa_group_segment_fixed_size 0
.amdhsa_kernarg_size 136
.amdhsa_user_sgpr_count 2
.amdhsa_user_sgpr_kernarg_segment_ptr 1
.amdhsa_system_sgpr_workgroup_id_x 1
.end_amdhsa_kernel
```
